```python
import torch

def _softmax(x, axis=-1):
    return torch.softmax(x, dim=axis)

def _gelu(x):
    return torch.nn.functional.gelu(x, approximate='tanh')

def _silu(x):
    return torch.nn.functional.silu(x)

def _sigmoid(x):
    return torch.sigmoid(x)

def _layernorm(x, axis=-1, eps=1e-05):
    m = x.mean(dim=axis, keepdim=True)
    v = x.var(dim=axis, keepdim=True, unbiased=False)
    return (x - m) / torch.sqrt(v + eps)

def _scatter_add(tgt, idx, src, axis=0):
    return tgt.clone().index_add_(axis, idx, src)

def _segment_sum(src, seg, n):
    out = torch.zeros((n,) + src.shape[1:], dtype=src.dtype)
    return out.index_add_(0, seg, src)

def _pad(x, pw):
    flat = tuple((v for pair in reversed(pw) for v in pair))
    return torch.nn.functional.pad(x, flat)
kernel_name = 'adaLN_cond__ssm_conv_s4__glu_gated_swiglu__prompt'

def setup_inputs():

    _w = lambda a: (lambda t: t.to(torch.bfloat16) if t.is_floating_point() else t)(torch.as_tensor(a))

    def _A_setup():
        B, L, D, N = (1, 2048, 512, 128)
        A_re = -(lambda _x: torch.exp(torch.as_tensor(_x)))((lambda *s: torch.randn(*s, dtype=torch.bfloat16) * 3.2)(D, N))
        A_im = torch.pi * (lambda *s: torch.randn(*s, dtype=torch.bfloat16) * 0.05)(D, N)
        B_re = (lambda *s: torch.randn(*s, dtype=torch.bfloat16) * 0.1)(D, N)
        B_im = (lambda *s: torch.randn(*s, dtype=torch.bfloat16) * 0.1)(D, N)
        C_re = (lambda *s: torch.randn(*s, dtype=torch.bfloat16) * 0.1)(D, N)
        C_im = (lambda *s: torch.randn(*s, dtype=torch.bfloat16) * 0.1)(D, N)
        log_dt = (lambda *s: torch.randn(*s, dtype=torch.bfloat16) * 0.05)(D) * 0.5 - 4.0
        Dskip = (lambda *s: torch.randn(*s, dtype=torch.bfloat16) * 0.05)(D)
        return {'u': _w((lambda *s: torch.randn(*s, dtype=torch.bfloat16) * 0.05)(B, L, D)), 'A_re': _w(A_re), 'A_im': _w(A_im), 'B_re': _w(B_re), 'B_im': _w(B_im), 'C_re': _w(C_re), 'C_im': _w(C_im), 'log_dt': _w(log_dt), 'Dskip': _w(Dskip)}
    _A_in = _A_setup()

    def _B_setup():
        B, S, D, F = (1, 2048, 512, 1792)
        return {'x': _w((lambda *s: torch.randn(*s, dtype=torch.bfloat16) * 0.05)(B, S, D)), 'w1': _w((lambda *s: torch.randn(*s, dtype=torch.bfloat16) * 0.4)(D, F) * (2.0 / D) ** 0.5), 'w3': _w((lambda *s: torch.randn(*s, dtype=torch.bfloat16) * 0.4)(D, F) * (2.0 / D) ** 0.5), 'w2': _w((lambda *s: torch.randn(*s, dtype=torch.bfloat16) * 0.4)(F, D) * (2.0 / F) ** 0.5)}
    _B_in = _B_setup()
    return {'A_u': _A_in['u'], 'A_A_re': _A_in['A_re'], 'A_A_im': _A_in['A_im'], 'A_B_re': _A_in['B_re'], 'A_B_im': _A_in['B_im'], 'A_C_re': _A_in['C_re'], 'A_C_im': _A_in['C_im'], 'A_log_dt': _A_in['log_dt'], 'A_Dskip': _A_in['Dskip'], 'B_x': _B_in['x'], 'B_w1': _B_in['w1'], 'B_w3': _B_in['w3'], 'B_w2': _B_in['w2'], 'c': _w((lambda *s: torch.randn(*s, dtype=torch.bfloat16) * 0.2)(1, 512) * 8.0), 'w_mod': _w((lambda *s: torch.randn(*s, dtype=torch.bfloat16) * 0.2)(512, 6 * 512) * 512 ** (-0.5) * 8.0)}

def reference(A_u, A_A_re, A_A_im, A_B_re, A_B_im, A_C_re, A_C_im, A_log_dt, A_Dskip, B_x, B_w1, B_w3, B_w2, c, w_mod):

    def _A_ref(u, A_re, A_im, B_re, B_im, C_re, C_im, log_dt, Dskip):
        Bsz, L, D = u.shape
        dt = torch.exp(log_dt)[:, None]
        A = A_re + 1j * A_im
        Bc = B_re + 1j * B_im
        Cc = C_re + 1j * C_im
        logdA = dt * A
        dB = dt * Bc
        l = (lambda x, dt: x.to(dt))(torch.arange(L), A_re.dtype)
        P = torch.exp(logdA[:, :, None] * l[None, None, :])
        K = torch.einsum('dn,dnl,dn->dl', Cc, P, dB).real
        L2 = 2 * L
        Kp = _pad(K, ((0, 0), (0, L)))
        up = (lambda x, *d: x.permute(*d))(u, 0, 2, 1)
        up = _pad(up, ((0, 0), (0, 0), (0, L)))
        Kf = (lambda x, axes=(-2, -1): torch.fft.rfft2(x.float(), dim=axes))(Kp[:, None, :], axes=(-2, -1))
        Uf = (lambda x, axes=(-2, -1): torch.fft.rfft2(x.float(), dim=axes))(up[:, :, None, :], axes=(-2, -1))
        Yf = Uf * Kf[None, :, :, :]
        y = (lambda x, s, axes=(-2, -1): torch.fft.irfft2(x, s=s, dim=axes).to(torch.bfloat16))(Yf, (1, L2), axes=(-2, -1))[:, :, 0, :L]
        y = (lambda x, *d: x.permute(*d))(y, 0, 2, 1) + u * Dskip[None, None, :]
        return y

    def _B_ref(x, w1, w3, w2):
        gate = torch.einsum('bsd,df->bsf', x, w1)
        up = torch.einsum('bsd,df->bsf', x, w3)
        h = _silu(gate) * up
        out = torch.einsum('bsf,fd->bsd', h, w2)
        return out
    x = A_u
    mod = (_silu(c) @ w_mod).reshape(c.shape[0], 6, 1, -1)
    sa, ca, ga, sb, cb, gb = (mod[:, 0].clone(), mod[:, 1].clone(), mod[:, 2].clone(), mod[:, 3].clone(), mod[:, 4].clone(), mod[:, 5].clone())
    h = _layernorm(x, axis=-1) * (1 + ca) + sa
    x = x + ga * _A_ref(h, A_A_re, A_A_im, A_B_re, A_B_im, A_C_re, A_C_im, A_log_dt, A_Dskip)
    h = _layernorm(x, axis=-1) * (1 + cb) + sb
    x = x + gb * _B_ref(h, B_w1, B_w3, B_w2)
    return x
```

```asm
; @launch kernel=kab_kernel grid=(256,1,1) block=(512,1,1) lds=147072
; @launch kernel=kc_kernel grid=(256,1,1) block=(512,1,1) lds=135232
.amdgcn_target "amdgcn-amd-amdhsa--gfx950"
.text
    .globl kab_kernel
    .p2align 8
    .type kab_kernel,@function
kab_kernel:
    s_cmp_ge_u32 s2, 256
    s_cbranch_scc1 KAB_END
    s_load_dwordx16 s[36:51], s[0:1], 0
    s_load_dwordx2 s[52:53], s[0:1], 64
    s_load_dwordx4 s[56:59], s[0:1], 80
    s_load_dwordx4 s[60:63], s[0:1], 104
    s_load_dwordx2 s[72:73], s[0:1], 96
    s_load_dwordx4 s[64:67], s[0:1], 128
    s_lshr_b32 s3, s2, 5
    s_and_b32 s20, s2, 7
    s_lshl_b32 s35, s20, 3
    s_add_u32 s3, s3, s35
    s_lshl_b32 s3, s3, 2
    s_bfe_u32 s20, s2, 0x20003
    s_add_u32 s3, s3, s20
    v_lshrrev_b32 v4, 6, v0
    v_and_b32 v1, 15, v0
    v_bfe_u32 v2, v0, 4, 4
    v_and_b32 v3, 63, v0
    v_readfirstlane_b32 s21, v4
    v_lshrrev_b32 v5, 8, v0
    s_lshl_b32 s22, s3, 1
    v_add_u32 v5, s22, v5
    v_lshlrev_b32 v6, 8, v5
    v_lshl_add_u32 v6, v2, 4, v6
    v_lshlrev_b32 v5, 1, v5
    s_lshl_b32 s22, s2, 3
    s_add_u32 s22, s22, s21
    s_lshl_b32 s23, s22, 10
    v_lshlrev_b32 v7, 4, v3
    s_movk_i32 s20, 6144
    v_lshrrev_b32 v99, 3, v0
    v_mul_lo_u32 v98, v99, s20
    v_and_b32 v94, 7, v0
    v_lshl_add_u32 v98, v94, 4, v98
    v_lshlrev_b32 v99, 1, v99
    s_and_b32 s33, s2, 3
    s_mul_i32 s35, s33, 786432
    s_lshr_b32 s32, s2, 2
    s_lshl_b32 s20, s32, 7
    s_add_u32 s35, s35, s20
    s_add_u32 s34, s35, 393216
    s_lshl_b32 s20, s33, 8
    s_waitcnt lgkmcnt(0)
    s_add_u32 s4, s36, 0
    s_addc_u32 s5, s37, 0
    s_mov_b32 s6, 2097152
    s_mov_b32 s7, 0x00020000
    buffer_load_dwordx4 v[100:103], v7, s[4:7], s23 offen
    s_add_u32 s8, s60, 0
    s_addc_u32 s9, s61, 0
    s_mov_b32 s10, 1024
    s_mov_b32 s11, 0x00020000
    s_add_u32 s12, s62, 0
    s_addc_u32 s13, s63, 0
    s_mov_b32 s14, 3145728
    s_mov_b32 s15, 0x00020000
    buffer_load_ushort v112, v99, s[8:11], s20 offen
    buffer_load_ushort v113, v99, s[8:11], s20 offen offset:128
    s_cmp_ge_u32 s2, 192
    s_cselect_b32 s14, 0, s14
    buffer_load_dwordx4 v[104:107], v98, s[12:15], s35 offen
    buffer_load_dwordx4 v[108:111], v98, s[12:15], s34 offen
    s_add_u32 s4, s50, 0
    s_addc_u32 s5, s51, 0
    s_mov_b32 s6, 1024
    s_mov_b32 s7, 0x00020000
    buffer_load_ushort v32, v5, s[4:7], 0 offen
    s_add_u32 s8, s38, 0
    s_addc_u32 s9, s39, 0
    s_mov_b32 s10, 131072
    s_mov_b32 s11, 0x00020000
    buffer_load_dwordx4 v[8:11], v6, s[8:11], 0 offen
    s_add_u32 s12, s40, 0
    s_addc_u32 s13, s41, 0
    s_mov_b32 s14, 131072
    s_mov_b32 s15, 0x00020000
    buffer_load_dwordx4 v[12:15], v6, s[12:15], 0 offen
    s_add_u32 s16, s42, 0
    s_addc_u32 s17, s43, 0
    s_mov_b32 s18, 131072
    s_mov_b32 s19, 0x00020000
    buffer_load_dwordx4 v[16:19], v6, s[16:19], 0 offen
    s_add_u32 s24, s44, 0
    s_addc_u32 s25, s45, 0
    s_mov_b32 s26, 131072
    s_mov_b32 s27, 0x00020000
    buffer_load_dwordx4 v[20:23], v6, s[24:27], 0 offen
    s_add_u32 s28, s46, 0
    s_addc_u32 s29, s47, 0
    s_mov_b32 s30, 131072
    s_mov_b32 s31, 0x00020000
    buffer_load_dwordx4 v[24:27], v6, s[28:31], 0 offen
    s_add_u32 s4, s48, 0
    s_addc_u32 s5, s49, 0
    s_mov_b32 s6, 131072
    s_mov_b32 s7, 0x00020000
    buffer_load_dwordx4 v[28:31], v6, s[4:7], 0 offen
    v_mov_b32 v40, 0x3f803f80
    v_mov_b32 v41, 0
    s_lshl_b32 s20, s21, 10
    s_add_u32 s20, s20, 115200
    v_add_u32 v43, s20, v7
    v_mov_b32 v44, 125504
    v_mov_b32 v45, 0
    ds_write_b32 v44, v45
    s_waitcnt vmcnt(11)
    ds_write_b128 v43, v[100:103]
    v_dot2c_f32_bf16 v41, v100, v40
    v_dot2c_f32_bf16 v41, v101, v40
    v_dot2c_f32_bf16 v41, v102, v40
    v_dot2c_f32_bf16 v41, v103, v40
    v_lshlrev_b32 v44, 16, v100
    v_and_b32 v45, 0xffff0000, v100
    v_lshlrev_b32 v46, 16, v101
    v_and_b32 v47, 0xffff0000, v101
    v_lshlrev_b32 v48, 16, v102
    v_and_b32 v49, 0xffff0000, v102
    v_lshlrev_b32 v50, 16, v103
    v_and_b32 v51, 0xffff0000, v103
    v_add_f32_dpp v41, v41, v41 row_shr:1 row_mask:0xf bank_mask:0xf bound_ctrl:0
    s_nop 1
    v_add_f32_dpp v41, v41, v41 row_shr:2 row_mask:0xf bank_mask:0xf bound_ctrl:0
    s_nop 1
    v_add_f32_dpp v41, v41, v41 row_shr:4 row_mask:0xf bank_mask:0xf bound_ctrl:0
    s_nop 1
    v_add_f32_dpp v41, v41, v41 row_shr:8 row_mask:0xf bank_mask:0xf bound_ctrl:0
    s_nop 1
    v_add_f32_dpp v41, v41, v41 row_bcast:15 row_mask:0xa bank_mask:0xf
    s_nop 1
    v_add_f32_dpp v41, v41, v41 row_bcast:31 row_mask:0xc bank_mask:0xf
    s_nop 1
    v_mul_f32 v41, 0x3b000000, v41
    v_mov_b32 v42, 0
    v_readlane_b32 s20, v41, 63
    s_nop 1
    v_subrev_f32 v44, s20, v44
    v_subrev_f32 v45, s20, v45
    v_subrev_f32 v46, s20, v46
    v_subrev_f32 v47, s20, v47
    v_subrev_f32 v48, s20, v48
    v_subrev_f32 v49, s20, v49
    v_subrev_f32 v50, s20, v50
    v_subrev_f32 v51, s20, v51
    v_fmac_f32 v42, v44, v44
    v_fmac_f32 v42, v45, v45
    v_fmac_f32 v42, v46, v46
    v_fmac_f32 v42, v47, v47
    v_fmac_f32 v42, v48, v48
    v_fmac_f32 v42, v49, v49
    v_fmac_f32 v42, v50, v50
    v_fmac_f32 v42, v51, v51
    s_nop 1
    v_add_f32_dpp v42, v42, v42 row_shr:1 row_mask:0xf bank_mask:0xf bound_ctrl:0
    s_nop 1
    v_add_f32_dpp v42, v42, v42 row_shr:2 row_mask:0xf bank_mask:0xf bound_ctrl:0
    s_nop 1
    v_add_f32_dpp v42, v42, v42 row_shr:4 row_mask:0xf bank_mask:0xf bound_ctrl:0
    s_nop 1
    v_add_f32_dpp v42, v42, v42 row_shr:8 row_mask:0xf bank_mask:0xf bound_ctrl:0
    s_nop 1
    v_add_f32_dpp v42, v42, v42 row_bcast:15 row_mask:0xa bank_mask:0xf
    s_nop 1
    v_add_f32_dpp v42, v42, v42 row_bcast:31 row_mask:0xc bank_mask:0xf
    s_nop 1
    v_mul_f32 v42, 0x3b000000, v42
    v_cvt_pk_bf16_f32 v41, v41, v41
    v_lshlrev_b32 v41, 16, v41
    v_cvt_pk_bf16_f32 v42, v42, v42
    v_lshlrev_b32 v42, 16, v42
    v_add_f32 v42, 0x3727c5ac, v42
    v_cvt_pk_bf16_f32 v42, v42, v42
    v_lshlrev_b32 v42, 16, v42
    v_sqrt_f32 v42, v42
    s_nop 0
    v_cvt_pk_bf16_f32 v42, v42, v42
    v_lshlrev_b32 v42, 16, v42
    s_add_u32 s40, s66, 1048576
    s_addc_u32 s41, s67, 0
    s_mov_b32 s42, 2097152
    s_mov_b32 s43, 0x00020000
    s_add_u32 s36, s66, 0
    s_addc_u32 s37, s67, 0
    s_mov_b32 s38, 1048576
    s_mov_b32 s39, 0x00020000
    v_lshrrev_b32 v41, 16, v41
    v_or_b32 v41, v41, v42
    s_lshl_b32 s20, s21, 2
    s_add_u32 s20, s20, 125440
    v_mov_b32 v43, s20
    s_mov_b32 exec_lo, 0
    s_mov_b32 exec_hi, 0x80000000
    ds_write_b32 v43, v41

    s_mov_b64 exec, -1
    s_waitcnt vmcnt(7)
    v_lshlrev_b32 v112, 16, v112
    v_mul_f32 v40, 0xbfb8aa3b, v112
    v_exp_f32 v40, v40
    s_nop 0
    v_add_f32 v40, 1.0, v40
    v_rcp_f32 v40, v40
    s_nop 0
    v_mul_f32 v112, v112, v40
    v_cvt_pk_bf16_f32 v112, v112, v112
    v_lshlrev_b32 v112, 16, v112
    v_lshlrev_b32 v113, 16, v113
    v_mul_f32 v40, 0xbfb8aa3b, v113
    v_exp_f32 v40, v40
    s_nop 0
    v_add_f32 v40, 1.0, v40
    v_rcp_f32 v40, v40
    s_nop 0
    v_mul_f32 v113, v113, v40
    v_cvt_pk_bf16_f32 v113, v113, v113
    v_lshlrev_b32 v113, 16, v113
    v_lshlrev_b32 v44, 16, v104
    v_and_b32 v45, 0xffff0000, v104
    v_lshlrev_b32 v46, 16, v105
    v_and_b32 v47, 0xffff0000, v105
    v_lshlrev_b32 v48, 16, v106
    v_and_b32 v49, 0xffff0000, v106
    v_lshlrev_b32 v50, 16, v107
    v_and_b32 v51, 0xffff0000, v107
    v_lshlrev_b32 v52, 16, v108
    v_and_b32 v53, 0xffff0000, v108
    v_lshlrev_b32 v54, 16, v109
    v_and_b32 v55, 0xffff0000, v109
    v_lshlrev_b32 v56, 16, v110
    v_and_b32 v57, 0xffff0000, v110
    v_lshlrev_b32 v58, 16, v111
    v_and_b32 v59, 0xffff0000, v111
    v_mul_f32 v44, v112, v44
    v_mul_f32 v45, v112, v45
    v_mul_f32 v46, v112, v46
    v_mul_f32 v47, v112, v47
    v_mul_f32 v48, v112, v48
    v_mul_f32 v49, v112, v49
    v_mul_f32 v50, v112, v50
    v_mul_f32 v51, v112, v51
    v_fmac_f32 v44, v113, v52
    v_fmac_f32 v45, v113, v53
    v_fmac_f32 v46, v113, v54
    v_fmac_f32 v47, v113, v55
    v_fmac_f32 v48, v113, v56
    v_fmac_f32 v49, v113, v57
    v_fmac_f32 v50, v113, v58
    v_fmac_f32 v51, v113, v59
    s_nop 1
    v_permlane32_swap_b32 v44, v48
    v_permlane32_swap_b32 v45, v49
    v_permlane32_swap_b32 v46, v50
    v_permlane32_swap_b32 v47, v51
    v_add_f32 v44, v44, v48
    v_add_f32 v45, v45, v49
    v_add_f32 v46, v46, v50
    v_add_f32 v47, v47, v51
    s_nop 1
    v_permlane16_swap_b32 v44, v46
    v_permlane16_swap_b32 v45, v47
    v_add_f32 v44, v44, v46
    v_add_f32 v45, v45, v47
    s_nop 1
    v_add_f32_dpp v44, v44, v44 row_shr:8 row_mask:0xf bank_mask:0xf bound_ctrl:0
    v_add_f32_dpp v45, v45, v45 row_shr:8 row_mask:0xf bank_mask:0xf bound_ctrl:0
    v_lshlrev_b32 v40, 8, v4
    v_lshl_add_u32 v40, v94, 5, v40
    v_bfe_u32 v41, v0, 4, 2
    v_lshl_add_u32 v40, v41, 3, v40
    v_add_u32 v40, 123392, v40
    s_mov_b32 exec_lo, 0xff00ff00
    s_mov_b32 exec_hi, 0xff00ff00
    ds_write_b64 v40, v[44:45]
    s_mov_b64 exec, -1
    v_lshlrev_b32 v43, 2, v3
    v_add_u32 v41, 123392, v43
    v_lshlrev_b32 v40, 1, v0
    v_add_u32 v40, 115200, v40
    v_lshlrev_b32 v42, 4, v0
    s_lshl_b32 s20, s2, 13
    s_waitcnt lgkmcnt(0)
    s_barrier
    ds_read_u16 v44, v40 offset:0
    ds_read_u16 v45, v40 offset:1024
    ds_read_u16 v46, v40 offset:2048
    ds_read_u16 v47, v40 offset:3072
    ds_read_u16 v48, v40 offset:4096
    ds_read_u16 v49, v40 offset:5120
    ds_read_u16 v50, v40 offset:6144
    ds_read_u16 v51, v40 offset:7168
    s_waitcnt lgkmcnt(0) vmcnt(0)
    v_lshl_or_b32 v60, v45, 16, v44
    v_lshl_or_b32 v61, v47, 16, v46
    v_lshl_or_b32 v62, v49, 16, v48
    v_lshl_or_b32 v63, v51, 16, v50
    buffer_store_dwordx4 v[60:63], v42, s[40:43], s20 offen sc1
    s_cmp_lg_u32 s21, 0
    s_cbranch_scc1 KAB_NU
    ds_read_b32 v52, v41 offset:0
    ds_read_b32 v53, v41 offset:256
    ds_read_b32 v54, v41 offset:512
    ds_read_b32 v55, v41 offset:768
    ds_read_b32 v56, v41 offset:1024
    ds_read_b32 v57, v41 offset:1280
    ds_read_b32 v58, v41 offset:1536
    ds_read_b32 v59, v41 offset:1792
    ds_read_b32 v44, v41 offset:2048
    s_lshl_b32 s22, s2, 5
    s_add_u32 s22, s22, 16384
    s_mul_i32 s23, s33, 12288
    s_lshl_b32 s20, s32, 8
    s_add_u32 s23, s23, s20
    s_add_u32 s23, s23, 131072
    s_waitcnt lgkmcnt(0)
    v_add_f32 v52, v52, v53
    v_add_f32 v52, v52, v54
    v_add_f32 v52, v52, v55
    v_add_f32 v52, v52, v56
    v_add_f32 v52, v52, v57
    v_add_f32 v52, v52, v58
    v_add_f32 v52, v52, v59
    s_mov_b64 exec, 0xff
    buffer_store_dword v44, v43, s[36:39], s22 offen sc1
    s_mov_b64 exec, -1
    s_cmp_lg_u32 s2, 200
    s_cbranch_scc1 KAB_NZ
    v_lshlrev_b32 v45, 6, v43
    v_mov_b32 v46, 0
    s_mov_b32 s20, 393216
    s_mov_b64 exec, 0xffff
    buffer_store_dword v46, v45, s[36:39], s20 offen
    s_mov_b64 exec, -1
KAB_NZ:
    s_cmp_ge_u32 s2, 192
    s_cbranch_scc1 KAB_NU
    buffer_store_dword v52, v43, s[36:39], s23 offen sc1
KAB_NU:
    s_setprio 3
    v_and_b32 v40, 7, v1
    v_lshrrev_b32 v41, 3, v1
    v_lshl_add_u32 v33, v41, 7, v40
    v_and_b32 v40, 3, v1
    v_bfe_u32 v41, v1, 2, 1
    v_lshlrev_b32 v40, 1, v40
    v_lshl_add_u32 v40, v41, 7, v40
    v_add_u32 v40, 256, v40
    v_and_b32 v41, 1, v1
    v_bfe_u32 v42, v1, 1, 2
    v_lshlrev_b32 v41, 2, v41
    v_lshl_add_u32 v41, v42, 7, v41
    v_add_u32 v41, 512, v41
    v_cmp_gt_u32 s[54:55], 8, v1
    v_lshlrev_b32 v35, 7, v1
    v_add_u32 v35, 1024, v35
    v_cndmask_b32 v34, v41, v40, s[54:55]
    v_and_b32 v40, 7, v2
    v_lshrrev_b32 v41, 3, v2
    v_lshl_add_u32 v176, v41, 7, v40
    v_and_b32 v40, 3, v2
    v_bfe_u32 v41, v2, 2, 1
    v_lshlrev_b32 v40, 1, v40
    v_lshl_add_u32 v40, v41, 7, v40
    v_add_u32 v40, 256, v40
    v_and_b32 v41, 1, v2
    v_bfe_u32 v42, v2, 1, 2
    v_lshlrev_b32 v41, 2, v41
    v_lshl_add_u32 v41, v42, 7, v41
    v_add_u32 v41, 512, v41
    v_cmp_gt_u32 s[70:71], 8, v2
    v_lshlrev_b32 v178, 7, v2
    v_add_u32 v178, 1024, v178
    v_cndmask_b32 v177, v41, v40, s[70:71]
    v_lshlrev_b32 v36, 3, v1
    v_lshrrev_b32 v97, 8, v0
    v_and_b32 v96, 255, v0
    v_mul_u32_u24 v95, 4352, v97
    v_add_u32 v95, 106496, v95
    v_lshl_add_u32 v192, v1, 3, v176
    v_lshl_add_u32 v193, v1, 3, v177
    v_lshl_add_u32 v194, v1, 3, v178
    v_min_u32 v194, 0x808, v194
    v_and_b32 v40, 1, v2
    v_sub_u32 v40, 1, v40
    v_cndmask_b32 v41, 1, 0, s[70:71]
    v_add_u32 v195, v40, v41
    v_cmp_eq_u32 vcc, 0x100, v193
    s_mov_b64 s[68:69], vcc
    v_cmp_eq_u32 vcc, 0x200, v193
    s_or_b64 vcc, vcc, s[68:69]
    s_nop 1
    v_cndmask_b32 v42, 0, 1, vcc
    v_sub_u32 v196, v195, v42
    v_and_b32 v40, 1, v1
    v_sub_u32 v197, 4, v40
    v_cmp_eq_u32 vcc, 0x400, v194
    s_nop 1
    v_cndmask_b32 v198, v197, 2, vcc
    v_lshl_add_u32 v192, v192, 1, v95
    v_lshl_add_u32 v193, v193, 1, v95
    v_lshl_add_u32 v194, v194, 1, v95
    v_cvt_f32_u32 v33, v33
    v_cvt_f32_u32 v34, v34
    v_cvt_f32_u32 v35, v35
    v_cvt_f32_u32 v36, v36
    v_lshlrev_b32 v32, 16, v32
    v_mul_f32 v32, 0x3fb8aa3b, v32
    v_exp_f32 v32, v32
    s_nop 0
    v_cvt_pk_bf16_f32 v32, v32, v32
    v_lshlrev_b32 v32, 16, v32
    v_lshlrev_b32 v40, 16, v8
    v_lshlrev_b32 v41, 16, v12
    v_and_b32 v42, 0xffff0000, v8
    v_and_b32 v43, 0xffff0000, v12
    v_lshlrev_b32 v44, 16, v9
    v_lshlrev_b32 v45, 16, v13
    v_and_b32 v46, 0xffff0000, v9
    v_and_b32 v47, 0xffff0000, v13
    v_lshlrev_b32 v48, 16, v10
    v_lshlrev_b32 v49, 16, v14
    v_and_b32 v50, 0xffff0000, v10
    v_and_b32 v51, 0xffff0000, v14
    v_lshlrev_b32 v52, 16, v11
    v_lshlrev_b32 v53, 16, v15
    v_and_b32 v54, 0xffff0000, v11
    v_and_b32 v55, 0xffff0000, v15
    v_mul_f32 v72, 0x3fb8aa3b, v32
    v_mul_f32 v73, 0x3e22f983, v32
    v_pk_mul_f32 v[40:41], v[40:41], v[72:73]
    v_pk_mul_f32 v[42:43], v[42:43], v[72:73]
    v_pk_mul_f32 v[44:45], v[44:45], v[72:73]
    v_pk_mul_f32 v[46:47], v[46:47], v[72:73]
    v_pk_mul_f32 v[48:49], v[48:49], v[72:73]
    v_pk_mul_f32 v[50:51], v[50:51], v[72:73]
    v_pk_mul_f32 v[52:53], v[52:53], v[72:73]
    v_pk_mul_f32 v[54:55], v[54:55], v[72:73]
    v_lshlrev_b32 v72, 16, v16
    v_lshlrev_b32 v73, 16, v20
    v_lshlrev_b32 v74, 16, v24
    v_lshlrev_b32 v75, 16, v28
    v_pk_mul_f32 v[72:73], v[72:73], v[32:33] op_sel_hi:[1,0]
    v_pk_mul_f32 v[56:57], v[72:73], v[74:75] op_sel_hi:[1,0]
    v_pk_fma_f32 v[56:57], v[72:73], v[74:75], v[56:57] op_sel:[1,1,0] op_sel_hi:[0,1,1] neg_lo:[1,0,0]
    v_and_b32 v72, 0xffff0000, v16
    v_and_b32 v73, 0xffff0000, v20
    v_and_b32 v74, 0xffff0000, v24
    v_and_b32 v75, 0xffff0000, v28
    v_pk_mul_f32 v[72:73], v[72:73], v[32:33] op_sel_hi:[1,0]
    v_pk_mul_f32 v[58:59], v[72:73], v[74:75] op_sel_hi:[1,0]
    v_pk_fma_f32 v[58:59], v[72:73], v[74:75], v[58:59] op_sel:[1,1,0] op_sel_hi:[0,1,1] neg_lo:[1,0,0]
    v_lshlrev_b32 v72, 16, v17
    v_lshlrev_b32 v73, 16, v21
    v_lshlrev_b32 v74, 16, v25
    v_lshlrev_b32 v75, 16, v29
    v_pk_mul_f32 v[72:73], v[72:73], v[32:33] op_sel_hi:[1,0]
    v_pk_mul_f32 v[60:61], v[72:73], v[74:75] op_sel_hi:[1,0]
    v_pk_fma_f32 v[60:61], v[72:73], v[74:75], v[60:61] op_sel:[1,1,0] op_sel_hi:[0,1,1] neg_lo:[1,0,0]
    v_and_b32 v72, 0xffff0000, v17
    v_and_b32 v73, 0xffff0000, v21
    v_and_b32 v74, 0xffff0000, v25
    v_and_b32 v75, 0xffff0000, v29
    v_pk_mul_f32 v[72:73], v[72:73], v[32:33] op_sel_hi:[1,0]
    v_pk_mul_f32 v[62:63], v[72:73], v[74:75] op_sel_hi:[1,0]
    v_pk_fma_f32 v[62:63], v[72:73], v[74:75], v[62:63] op_sel:[1,1,0] op_sel_hi:[0,1,1] neg_lo:[1,0,0]
    v_lshlrev_b32 v72, 16, v18
    v_lshlrev_b32 v73, 16, v22
    v_lshlrev_b32 v74, 16, v26
    v_lshlrev_b32 v75, 16, v30
    v_pk_mul_f32 v[72:73], v[72:73], v[32:33] op_sel_hi:[1,0]
    v_pk_mul_f32 v[64:65], v[72:73], v[74:75] op_sel_hi:[1,0]
    v_pk_fma_f32 v[64:65], v[72:73], v[74:75], v[64:65] op_sel:[1,1,0] op_sel_hi:[0,1,1] neg_lo:[1,0,0]
    v_and_b32 v72, 0xffff0000, v18
    v_and_b32 v73, 0xffff0000, v22
    v_and_b32 v74, 0xffff0000, v26
    v_and_b32 v75, 0xffff0000, v30
    v_pk_mul_f32 v[72:73], v[72:73], v[32:33] op_sel_hi:[1,0]
    v_pk_mul_f32 v[66:67], v[72:73], v[74:75] op_sel_hi:[1,0]
    v_pk_fma_f32 v[66:67], v[72:73], v[74:75], v[66:67] op_sel:[1,1,0] op_sel_hi:[0,1,1] neg_lo:[1,0,0]
    v_lshlrev_b32 v72, 16, v19
    v_lshlrev_b32 v73, 16, v23
    v_lshlrev_b32 v74, 16, v27
    v_lshlrev_b32 v75, 16, v31
    v_pk_mul_f32 v[72:73], v[72:73], v[32:33] op_sel_hi:[1,0]
    v_pk_mul_f32 v[68:69], v[72:73], v[74:75] op_sel_hi:[1,0]
    v_pk_fma_f32 v[68:69], v[72:73], v[74:75], v[68:69] op_sel:[1,1,0] op_sel_hi:[0,1,1] neg_lo:[1,0,0]
    v_and_b32 v72, 0xffff0000, v19
    v_and_b32 v73, 0xffff0000, v23
    v_and_b32 v74, 0xffff0000, v27
    v_and_b32 v75, 0xffff0000, v31
    v_pk_mul_f32 v[72:73], v[72:73], v[32:33] op_sel_hi:[1,0]
    v_pk_mul_f32 v[70:71], v[72:73], v[74:75] op_sel_hi:[1,0]
    v_pk_fma_f32 v[70:71], v[72:73], v[74:75], v[70:71] op_sel:[1,1,0] op_sel_hi:[0,1,1] neg_lo:[1,0,0]
    s_add_u32 s4, s64, 0
    s_addc_u32 s5, s65, 0
    s_mov_b32 s6, 256
    s_mov_b32 s7, 0x00020000
    v_mov_b32 v92, 1
    v_mov_b32 v93, 125504
    s_mov_b64 exec, 1
    s_waitcnt vmcnt(0)
    ds_add_rtn_u32 v94, v93, v92
    v_mov_b32 v93, 0
    s_and_b32 s20, s2, 3
    s_lshl_b32 s20, s20, 6
    s_waitcnt lgkmcnt(0)
    v_readfirstlane_b32 s22, v94
    s_cmp_lg_u32 s22, 7
    s_cbranch_scc1 KAB_NA
    buffer_atomic_add v92, v93, s[4:7], s20 offen sc1
KAB_NA:
    s_setprio 0
    s_mov_b64 exec, -1
    s_cmp_lt_u32 s21, 4
    s_cbranch_scc1 KAB_NW
    s_cmp_ge_u32 s2, 224
    s_cbranch_scc1 KAB_W2L
    s_and_b32 s20, s2, 1
    s_cmp_eq_u32 s20, 0
    s_cselect_b32 s44, s56, s58
    s_cselect_b32 s45, s57, s59
    s_mov_b32 s46, 1835008
    s_mov_b32 s47, 0x00020000
    s_cmp_ge_u32 s2, 224
    s_cselect_b32 s46, 0, s46
    v_and_b32 v113, 31, v0
    v_bfe_u32 v114, v0, 5, 3
    s_bfe_u32 s30, s2, 0x20001
    s_lshr_b32 s31, s2, 3
    s_lshl_b32 s20, s30, 3
    v_add_u32 v114, s20, v114
    s_mov_b32 s20, 57344
    v_mul_lo_u32 v115, v114, s20
    v_lshl_add_u32 v115, v113, 2, v115
    s_lshl_b32 s20, s31, 7
    buffer_load_dword v116, v115, s[44:47], s20 offen
    s_add_u32 s20, s20, 3584
    buffer_load_dword v117, v115, s[44:47], s20 offen
    s_add_u32 s20, s20, 3584
    buffer_load_dword v118, v115, s[44:47], s20 offen
    s_add_u32 s20, s20, 3584
    buffer_load_dword v119, v115, s[44:47], s20 offen
    s_add_u32 s20, s20, 3584
    buffer_load_dword v120, v115, s[44:47], s20 offen
    s_add_u32 s20, s20, 3584
    buffer_load_dword v121, v115, s[44:47], s20 offen
    s_add_u32 s20, s20, 3584
    buffer_load_dword v122, v115, s[44:47], s20 offen
    s_add_u32 s20, s20, 3584
    buffer_load_dword v123, v115, s[44:47], s20 offen
    s_add_u32 s20, s20, 3584
    buffer_load_dword v124, v115, s[44:47], s20 offen
    s_add_u32 s20, s20, 3584
    buffer_load_dword v125, v115, s[44:47], s20 offen
    s_add_u32 s20, s20, 3584
    buffer_load_dword v126, v115, s[44:47], s20 offen
    s_add_u32 s20, s20, 3584
    buffer_load_dword v127, v115, s[44:47], s20 offen
    s_add_u32 s20, s20, 3584
    buffer_load_dword v128, v115, s[44:47], s20 offen
    s_add_u32 s20, s20, 3584
    buffer_load_dword v129, v115, s[44:47], s20 offen
    s_add_u32 s20, s20, 3584
    buffer_load_dword v130, v115, s[44:47], s20 offen
    s_add_u32 s20, s20, 3584
    buffer_load_dword v131, v115, s[44:47], s20 offen
    s_add_u32 s20, s20, 3584
    s_branch KAB_NW
KAB_W2L:
    s_add_u32 s44, s72, 0
    s_addc_u32 s45, s73, 0
    s_mov_b32 s46, 1835008
    s_mov_b32 s47, 0x00020000
    v_lshlrev_b32 v115, 2, v96
    s_sub_u32 s31, s2, 224
    s_mul_i32 s20, s31, 57344
    s_mov_b32 s30, 0
    buffer_load_dword v116, v115, s[44:47], s20 offen offset:0
    buffer_load_dword v117, v115, s[44:47], s20 offen offset:1024
    buffer_load_dword v118, v115, s[44:47], s20 offen offset:2048
    buffer_load_dword v119, v115, s[44:47], s20 offen offset:3072
    s_add_u32 s20, s20, 4096
    buffer_load_dword v120, v115, s[44:47], s20 offen offset:0
    buffer_load_dword v121, v115, s[44:47], s20 offen offset:1024
    buffer_load_dword v122, v115, s[44:47], s20 offen offset:2048
    buffer_load_dword v123, v115, s[44:47], s20 offen offset:3072
    s_add_u32 s20, s20, 4096
    buffer_load_dword v124, v115, s[44:47], s20 offen offset:0
    buffer_load_dword v125, v115, s[44:47], s20 offen offset:1024
    buffer_load_dword v126, v115, s[44:47], s20 offen offset:2048
    buffer_load_dword v127, v115, s[44:47], s20 offen offset:3072
    s_add_u32 s20, s20, 4096
    buffer_load_dword v128, v115, s[44:47], s20 offen offset:0
    buffer_load_dword v129, v115, s[44:47], s20 offen offset:1024
    buffer_load_dword v130, v115, s[44:47], s20 offen offset:2048
    buffer_load_dword v131, v115, s[44:47], s20 offen offset:3072
    s_add_u32 s20, s20, 4096
    buffer_load_dword v220, v115, s[44:47], s20 offen offset:0
    buffer_load_dword v221, v115, s[44:47], s20 offen offset:1024
    buffer_load_dword v222, v115, s[44:47], s20 offen offset:2048
    buffer_load_dword v223, v115, s[44:47], s20 offen offset:3072
    s_add_u32 s20, s20, 4096
    buffer_load_dword v224, v115, s[44:47], s20 offen offset:0
    buffer_load_dword v225, v115, s[44:47], s20 offen offset:1024
    buffer_load_dword v226, v115, s[44:47], s20 offen offset:2048
    buffer_load_dword v227, v115, s[44:47], s20 offen offset:3072
    s_add_u32 s20, s20, 4096
    buffer_load_dword v228, v115, s[44:47], s20 offen offset:0
    buffer_load_dword v229, v115, s[44:47], s20 offen offset:1024
    buffer_load_dword v230, v115, s[44:47], s20 offen offset:2048
    buffer_load_dword v231, v115, s[44:47], s20 offen offset:3072
    s_add_u32 s20, s20, 4096
    buffer_load_dword v232, v115, s[44:47], s20 offen offset:0
    buffer_load_dword v233, v115, s[44:47], s20 offen offset:1024
    buffer_load_dword v234, v115, s[44:47], s20 offen offset:2048
    buffer_load_dword v235, v115, s[44:47], s20 offen offset:3072
    s_add_u32 s20, s20, 4096
    buffer_load_dword v236, v115, s[44:47], s20 offen offset:0
    buffer_load_dword v237, v115, s[44:47], s20 offen offset:1024
    buffer_load_dword v238, v115, s[44:47], s20 offen offset:2048
    buffer_load_dword v239, v115, s[44:47], s20 offen offset:3072
    s_add_u32 s20, s20, 4096
    buffer_load_dword v240, v115, s[44:47], s20 offen offset:0
    buffer_load_dword v241, v115, s[44:47], s20 offen offset:1024
    buffer_load_dword v242, v115, s[44:47], s20 offen offset:2048
    buffer_load_dword v243, v115, s[44:47], s20 offen offset:3072
    s_add_u32 s20, s20, 4096
    buffer_load_dword v244, v115, s[44:47], s20 offen offset:0
    buffer_load_dword v245, v115, s[44:47], s20 offen offset:1024
    buffer_load_dword v246, v115, s[44:47], s20 offen offset:2048
    buffer_load_dword v247, v115, s[44:47], s20 offen offset:3072
    s_add_u32 s20, s20, 4096
    buffer_load_dword v248, v115, s[44:47], s20 offen offset:0
    buffer_load_dword v249, v115, s[44:47], s20 offen offset:1024
    buffer_load_dword v250, v115, s[44:47], s20 offen offset:2048
    buffer_load_dword v251, v115, s[44:47], s20 offen offset:3072
    s_add_u32 s20, s20, 4096
    buffer_load_dword v176, v115, s[44:47], s20 offen offset:0
    buffer_load_dword v177, v115, s[44:47], s20 offen offset:1024
    buffer_load_dword v178, v115, s[44:47], s20 offen offset:2048
    buffer_load_dword v179, v115, s[44:47], s20 offen offset:3072
    s_add_u32 s20, s20, 4096
    buffer_load_dword v180, v115, s[44:47], s20 offen offset:0
    buffer_load_dword v181, v115, s[44:47], s20 offen offset:1024
    buffer_load_dword v182, v115, s[44:47], s20 offen offset:2048
    buffer_load_dword v183, v115, s[44:47], s20 offen offset:3072
    s_add_u32 s20, s20, 4096
KAB_NW:
    v_pk_mul_f32 v[72:73], v[40:41], v[36:37] op_sel_hi:[1,0]
    v_pk_mul_f32 v[74:75], v[42:43], v[36:37] op_sel_hi:[1,0]
    v_pk_mul_f32 v[76:77], v[44:45], v[36:37] op_sel_hi:[1,0]
    v_pk_mul_f32 v[78:79], v[46:47], v[36:37] op_sel_hi:[1,0]
    v_fract_f32 v73, v73
    v_fract_f32 v75, v75
    v_fract_f32 v77, v77
    v_fract_f32 v79, v79
    v_exp_f32 v72, v72
    v_cos_f32 v80, v73
    v_sin_f32 v81, v73
    v_exp_f32 v74, v74
    v_cos_f32 v82, v75
    v_sin_f32 v83, v75
    v_exp_f32 v76, v76
    v_cos_f32 v84, v77
    v_sin_f32 v85, v77
    v_exp_f32 v78, v78
    v_cos_f32 v86, v79
    v_sin_f32 v87, v79
    v_pk_mul_f32 v[80:81], v[80:81], v[72:73] op_sel_hi:[1,0]
    v_pk_mul_f32 v[82:83], v[82:83], v[74:75] op_sel_hi:[1,0]
    v_pk_mul_f32 v[84:85], v[84:85], v[76:77] op_sel_hi:[1,0]
    v_pk_mul_f32 v[86:87], v[86:87], v[78:79] op_sel_hi:[1,0]
    v_pk_mul_f32 v[72:73], v[80:81], v[56:57] op_sel_hi:[1,0] neg_hi:[1,0]
    v_pk_fma_f32 v[72:73], v[80:81], v[56:57], v[72:73] op_sel:[1,1,0] op_sel_hi:[0,1,1] neg_lo:[1,0,0] neg_hi:[1,0,0]
    v_cvt_pk_bf16_f32 v8, v72, v73
    v_pk_mul_f32 v[74:75], v[82:83], v[58:59] op_sel_hi:[1,0] neg_hi:[1,0]
    v_pk_fma_f32 v[74:75], v[82:83], v[58:59], v[74:75] op_sel:[1,1,0] op_sel_hi:[0,1,1] neg_lo:[1,0,0] neg_hi:[1,0,0]
    v_cvt_pk_bf16_f32 v9, v74, v75
    v_pk_mul_f32 v[76:77], v[84:85], v[60:61] op_sel_hi:[1,0] neg_hi:[1,0]
    v_pk_fma_f32 v[76:77], v[84:85], v[60:61], v[76:77] op_sel:[1,1,0] op_sel_hi:[0,1,1] neg_lo:[1,0,0] neg_hi:[1,0,0]
    v_cvt_pk_bf16_f32 v10, v76, v77
    v_pk_mul_f32 v[78:79], v[86:87], v[62:63] op_sel_hi:[1,0] neg_hi:[1,0]
    v_pk_fma_f32 v[78:79], v[86:87], v[62:63], v[78:79] op_sel:[1,1,0] op_sel_hi:[0,1,1] neg_lo:[1,0,0] neg_hi:[1,0,0]
    v_cvt_pk_bf16_f32 v11, v78, v79
    v_pk_mul_f32 v[72:73], v[40:41], v[32:33] op_sel:[0,1] op_sel_hi:[1,1]
    v_pk_mul_f32 v[74:75], v[42:43], v[32:33] op_sel:[0,1] op_sel_hi:[1,1]
    v_pk_mul_f32 v[76:77], v[44:45], v[32:33] op_sel:[0,1] op_sel_hi:[1,1]
    v_pk_mul_f32 v[78:79], v[46:47], v[32:33] op_sel:[0,1] op_sel_hi:[1,1]
    v_fract_f32 v73, v73
    v_fract_f32 v75, v75
    v_fract_f32 v77, v77
    v_fract_f32 v79, v79
    v_exp_f32 v72, v72
    v_cos_f32 v80, v73
    v_sin_f32 v81, v73
    v_exp_f32 v74, v74
    v_cos_f32 v82, v75
    v_sin_f32 v83, v75
    v_exp_f32 v76, v76
    v_cos_f32 v84, v77
    v_sin_f32 v85, v77
    v_exp_f32 v78, v78
    v_cos_f32 v86, v79
    v_sin_f32 v87, v79
    v_pk_mul_f32 v[80:81], v[80:81], v[72:73] op_sel_hi:[1,0]
    v_pk_mul_f32 v[82:83], v[82:83], v[74:75] op_sel_hi:[1,0]
    v_pk_mul_f32 v[84:85], v[84:85], v[76:77] op_sel_hi:[1,0]
    v_pk_mul_f32 v[86:87], v[86:87], v[78:79] op_sel_hi:[1,0]
    v_cvt_pk_bf16_f32 v12, v80, v81
    v_cvt_pk_bf16_f32 v13, v82, v83
    v_cvt_pk_bf16_f32 v14, v84, v85
    v_cvt_pk_bf16_f32 v15, v86, v87
    s_nop 1
    v_mfma_f32_16x16x32_bf16 v[132:135], v[12:15], v[8:11], 0
    v_pk_mul_f32 v[72:73], v[40:41], v[34:35] op_sel_hi:[1,0]
    v_pk_mul_f32 v[74:75], v[42:43], v[34:35] op_sel_hi:[1,0]
    v_pk_mul_f32 v[76:77], v[44:45], v[34:35] op_sel_hi:[1,0]
    v_pk_mul_f32 v[78:79], v[46:47], v[34:35] op_sel_hi:[1,0]
    v_fract_f32 v73, v73
    v_fract_f32 v75, v75
    v_fract_f32 v77, v77
    v_fract_f32 v79, v79
    v_exp_f32 v72, v72
    v_cos_f32 v80, v73
    v_sin_f32 v81, v73
    v_exp_f32 v74, v74
    v_cos_f32 v82, v75
    v_sin_f32 v83, v75
    v_exp_f32 v76, v76
    v_cos_f32 v84, v77
    v_sin_f32 v85, v77
    v_exp_f32 v78, v78
    v_cos_f32 v86, v79
    v_sin_f32 v87, v79
    v_pk_mul_f32 v[80:81], v[80:81], v[72:73] op_sel_hi:[1,0]
    v_pk_mul_f32 v[82:83], v[82:83], v[74:75] op_sel_hi:[1,0]
    v_pk_mul_f32 v[84:85], v[84:85], v[76:77] op_sel_hi:[1,0]
    v_pk_mul_f32 v[86:87], v[86:87], v[78:79] op_sel_hi:[1,0]
    v_cvt_pk_bf16_f32 v16, v80, v81
    v_cvt_pk_bf16_f32 v17, v82, v83
    v_cvt_pk_bf16_f32 v18, v84, v85
    v_cvt_pk_bf16_f32 v19, v86, v87
    s_nop 1
    v_mfma_f32_16x16x32_bf16 v[136:139], v[16:19], v[8:11], 0
    v_pk_mul_f32 v[72:73], v[40:41], v[34:35] op_sel:[0,1] op_sel_hi:[1,1]
    v_pk_mul_f32 v[74:75], v[42:43], v[34:35] op_sel:[0,1] op_sel_hi:[1,1]
    v_pk_mul_f32 v[76:77], v[44:45], v[34:35] op_sel:[0,1] op_sel_hi:[1,1]
    v_pk_mul_f32 v[78:79], v[46:47], v[34:35] op_sel:[0,1] op_sel_hi:[1,1]
    v_fract_f32 v73, v73
    v_fract_f32 v75, v75
    v_fract_f32 v77, v77
    v_fract_f32 v79, v79
    v_exp_f32 v72, v72
    v_cos_f32 v80, v73
    v_sin_f32 v81, v73
    v_exp_f32 v74, v74
    v_cos_f32 v82, v75
    v_sin_f32 v83, v75
    v_exp_f32 v76, v76
    v_cos_f32 v84, v77
    v_sin_f32 v85, v77
    v_exp_f32 v78, v78
    v_cos_f32 v86, v79
    v_sin_f32 v87, v79
    v_pk_mul_f32 v[80:81], v[80:81], v[72:73] op_sel_hi:[1,0]
    v_pk_mul_f32 v[82:83], v[82:83], v[74:75] op_sel_hi:[1,0]
    v_pk_mul_f32 v[84:85], v[84:85], v[76:77] op_sel_hi:[1,0]
    v_pk_mul_f32 v[86:87], v[86:87], v[78:79] op_sel_hi:[1,0]
    v_cvt_pk_bf16_f32 v20, v80, v81
    v_cvt_pk_bf16_f32 v21, v82, v83
    v_cvt_pk_bf16_f32 v22, v84, v85
    v_cvt_pk_bf16_f32 v23, v86, v87
    s_nop 1
    v_mfma_f32_16x16x32_bf16 v[140:143], v[20:23], v[8:11], 0
    v_pk_mul_f32 v[72:73], v[48:49], v[36:37] op_sel_hi:[1,0]
    v_pk_mul_f32 v[74:75], v[50:51], v[36:37] op_sel_hi:[1,0]
    v_pk_mul_f32 v[76:77], v[52:53], v[36:37] op_sel_hi:[1,0]
    v_pk_mul_f32 v[78:79], v[54:55], v[36:37] op_sel_hi:[1,0]
    v_fract_f32 v73, v73
    v_fract_f32 v75, v75
    v_fract_f32 v77, v77
    v_fract_f32 v79, v79
    v_exp_f32 v72, v72
    v_cos_f32 v80, v73
    v_sin_f32 v81, v73
    v_exp_f32 v74, v74
    v_cos_f32 v82, v75
    v_sin_f32 v83, v75
    v_exp_f32 v76, v76
    v_cos_f32 v84, v77
    v_sin_f32 v85, v77
    v_exp_f32 v78, v78
    v_cos_f32 v86, v79
    v_sin_f32 v87, v79
    v_pk_mul_f32 v[80:81], v[80:81], v[72:73] op_sel_hi:[1,0]
    v_pk_mul_f32 v[82:83], v[82:83], v[74:75] op_sel_hi:[1,0]
    v_pk_mul_f32 v[84:85], v[84:85], v[76:77] op_sel_hi:[1,0]
    v_pk_mul_f32 v[86:87], v[86:87], v[78:79] op_sel_hi:[1,0]
    v_pk_mul_f32 v[72:73], v[80:81], v[64:65] op_sel_hi:[1,0] neg_hi:[1,0]
    v_pk_fma_f32 v[72:73], v[80:81], v[64:65], v[72:73] op_sel:[1,1,0] op_sel_hi:[0,1,1] neg_lo:[1,0,0] neg_hi:[1,0,0]
    v_cvt_pk_bf16_f32 v8, v72, v73
    v_pk_mul_f32 v[74:75], v[82:83], v[66:67] op_sel_hi:[1,0] neg_hi:[1,0]
    v_pk_fma_f32 v[74:75], v[82:83], v[66:67], v[74:75] op_sel:[1,1,0] op_sel_hi:[0,1,1] neg_lo:[1,0,0] neg_hi:[1,0,0]
    v_cvt_pk_bf16_f32 v9, v74, v75
    v_pk_mul_f32 v[76:77], v[84:85], v[68:69] op_sel_hi:[1,0] neg_hi:[1,0]
    v_pk_fma_f32 v[76:77], v[84:85], v[68:69], v[76:77] op_sel:[1,1,0] op_sel_hi:[0,1,1] neg_lo:[1,0,0] neg_hi:[1,0,0]
    v_cvt_pk_bf16_f32 v10, v76, v77
    v_pk_mul_f32 v[78:79], v[86:87], v[70:71] op_sel_hi:[1,0] neg_hi:[1,0]
    v_pk_fma_f32 v[78:79], v[86:87], v[70:71], v[78:79] op_sel:[1,1,0] op_sel_hi:[0,1,1] neg_lo:[1,0,0] neg_hi:[1,0,0]
    v_cvt_pk_bf16_f32 v11, v78, v79
    v_pk_mul_f32 v[72:73], v[48:49], v[32:33] op_sel:[0,1] op_sel_hi:[1,1]
    v_pk_mul_f32 v[74:75], v[50:51], v[32:33] op_sel:[0,1] op_sel_hi:[1,1]
    v_pk_mul_f32 v[76:77], v[52:53], v[32:33] op_sel:[0,1] op_sel_hi:[1,1]
    v_pk_mul_f32 v[78:79], v[54:55], v[32:33] op_sel:[0,1] op_sel_hi:[1,1]
    v_fract_f32 v73, v73
    v_fract_f32 v75, v75
    v_fract_f32 v77, v77
    v_fract_f32 v79, v79
    v_exp_f32 v72, v72
    v_cos_f32 v80, v73
    v_sin_f32 v81, v73
    v_exp_f32 v74, v74
    v_cos_f32 v82, v75
    v_sin_f32 v83, v75
    v_exp_f32 v76, v76
    v_cos_f32 v84, v77
    v_sin_f32 v85, v77
    v_exp_f32 v78, v78
    v_cos_f32 v86, v79
    v_sin_f32 v87, v79
    v_pk_mul_f32 v[80:81], v[80:81], v[72:73] op_sel_hi:[1,0]
    v_pk_mul_f32 v[82:83], v[82:83], v[74:75] op_sel_hi:[1,0]
    v_pk_mul_f32 v[84:85], v[84:85], v[76:77] op_sel_hi:[1,0]
    v_pk_mul_f32 v[86:87], v[86:87], v[78:79] op_sel_hi:[1,0]
    v_cvt_pk_bf16_f32 v12, v80, v81
    v_cvt_pk_bf16_f32 v13, v82, v83
    v_cvt_pk_bf16_f32 v14, v84, v85
    v_cvt_pk_bf16_f32 v15, v86, v87
    s_nop 1
    v_mfma_f32_16x16x32_bf16 v[132:135], v[12:15], v[8:11], v[132:135]
    v_pk_mul_f32 v[72:73], v[48:49], v[34:35] op_sel_hi:[1,0]
    v_pk_mul_f32 v[74:75], v[50:51], v[34:35] op_sel_hi:[1,0]
    v_pk_mul_f32 v[76:77], v[52:53], v[34:35] op_sel_hi:[1,0]
    v_pk_mul_f32 v[78:79], v[54:55], v[34:35] op_sel_hi:[1,0]
    v_fract_f32 v73, v73
    v_fract_f32 v75, v75
    v_fract_f32 v77, v77
    v_fract_f32 v79, v79
    v_exp_f32 v72, v72
    v_cos_f32 v80, v73
    v_sin_f32 v81, v73
    v_exp_f32 v74, v74
    v_cos_f32 v82, v75
    v_sin_f32 v83, v75
    v_exp_f32 v76, v76
    v_cos_f32 v84, v77
    v_sin_f32 v85, v77
    v_exp_f32 v78, v78
    v_cos_f32 v86, v79
    v_sin_f32 v87, v79
    v_pk_mul_f32 v[80:81], v[80:81], v[72:73] op_sel_hi:[1,0]
    v_pk_mul_f32 v[82:83], v[82:83], v[74:75] op_sel_hi:[1,0]
    v_pk_mul_f32 v[84:85], v[84:85], v[76:77] op_sel_hi:[1,0]
    v_pk_mul_f32 v[86:87], v[86:87], v[78:79] op_sel_hi:[1,0]
    v_cvt_pk_bf16_f32 v16, v80, v81
    v_cvt_pk_bf16_f32 v17, v82, v83
    v_cvt_pk_bf16_f32 v18, v84, v85
    v_cvt_pk_bf16_f32 v19, v86, v87
    s_nop 1
    v_mfma_f32_16x16x32_bf16 v[136:139], v[16:19], v[8:11], v[136:139]
    v_pk_mul_f32 v[72:73], v[48:49], v[34:35] op_sel:[0,1] op_sel_hi:[1,1]
    v_pk_mul_f32 v[74:75], v[50:51], v[34:35] op_sel:[0,1] op_sel_hi:[1,1]
    v_pk_mul_f32 v[76:77], v[52:53], v[34:35] op_sel:[0,1] op_sel_hi:[1,1]
    v_pk_mul_f32 v[78:79], v[54:55], v[34:35] op_sel:[0,1] op_sel_hi:[1,1]
    v_fract_f32 v73, v73
    v_fract_f32 v75, v75
    v_fract_f32 v77, v77
    v_fract_f32 v79, v79
    v_exp_f32 v72, v72
    v_cos_f32 v80, v73
    v_sin_f32 v81, v73
    v_exp_f32 v74, v74
    v_cos_f32 v82, v75
    v_sin_f32 v83, v75
    v_exp_f32 v76, v76
    v_cos_f32 v84, v77
    v_sin_f32 v85, v77
    v_exp_f32 v78, v78
    v_cos_f32 v86, v79
    v_sin_f32 v87, v79
    v_pk_mul_f32 v[80:81], v[80:81], v[72:73] op_sel_hi:[1,0]
    v_pk_mul_f32 v[82:83], v[82:83], v[74:75] op_sel_hi:[1,0]
    v_pk_mul_f32 v[84:85], v[84:85], v[76:77] op_sel_hi:[1,0]
    v_pk_mul_f32 v[86:87], v[86:87], v[78:79] op_sel_hi:[1,0]
    v_cvt_pk_bf16_f32 v20, v80, v81
    v_cvt_pk_bf16_f32 v21, v82, v83
    v_cvt_pk_bf16_f32 v22, v84, v85
    v_cvt_pk_bf16_f32 v23, v86, v87
    s_nop 1
    v_mfma_f32_16x16x32_bf16 v[140:143], v[20:23], v[8:11], v[140:143]
    v_mul_u32_u24 v5, 3072, v4
    v_lshl_add_u32 v5, v3, 4, v5
    v_add_u32 v5, 81920, v5
    v_mul_u32_u24 v6, 12288, v97
    v_lshrrev_b32 v7, 2, v2
    v_lshl_add_u32 v6, v7, 8, v6
    v_lshl_add_u32 v6, v1, 4, v6
    v_and_b32 v7, 3, v2
    v_lshl_add_u32 v6, v7, 2, v6
    v_add_u32 v10, 81920, v6
    ds_write_b128 v5, v[132:135] offset:0
    ds_write_b128 v5, v[136:139] offset:1024
    ds_write_b128 v5, v[140:143] offset:2048
    v_mov_b32 v12, 0
    v_mov_b32 v13, 0
    v_mov_b32 v14, 0
    v_mov_b32 v15, 0
    ds_write_b128 v95, v[12:15]
    v_mul_u32_u24 v11, 4160, v1
    ds_write_b128 v11, v[12:15]
    ds_write_b128 v11, v[12:15] offset:16
    ds_write_b128 v11, v[12:15] offset:32
    v_min_u32 v11, 159, v96
    v_lshlrev_b32 v11, 4, v11
    v_mul_u32_u24 v16, 7680, v97
    v_add_u32 v11, v11, v16
    v_add_u32 v11, 66560, v11
    ds_write_b128 v11, v[12:15]
    s_cmp_lg_u32 s21, 0
    s_cbranch_scc1 KAB_NP
    v_lshlrev_b32 v92, 6, v3
    s_mov_b64 exec, 0xf
KAB_POLL:
    s_sleep 8
    buffer_load_dword v93, v92, s[4:7], 0 offen sc1
    s_waitcnt vmcnt(0)
    v_cmp_gt_u32 vcc, 64, v93
    s_nop 4
    s_cbranch_vccz KAB_PD
    s_branch KAB_POLL
KAB_PD:
    s_mov_b64 exec, -1
KAB_NP:
    s_waitcnt lgkmcnt(0)
    s_barrier
    s_cmp_lg_u32 s21, 1
    s_cbranch_scc1 KAB_L2
    v_and_b32 v7, 3, v0
    v_mul_u32_u24 v7, 12288, v7
    v_bfe_u32 v8, v0, 2, 1
    v_lshl_add_u32 v7, v8, 2, v7
    v_bfe_u32 v8, v0, 3, 2
    v_lshl_add_u32 v7, v8, 11, v7
    s_lshl_b32 s20, s3, 3
    s_add_u32 s20, s20, 131072
    buffer_load_dword v200, v7, s[36:39], s20 offen sc1
KAB_L2:
    v_lshrrev_b32 v5, 1, v0
    v_and_b32 v6, 1, v0
    v_lshlrev_b32 v7, 13, v5
    v_lshl_add_u32 v7, v6, 4, v7
    s_lshl_b32 s22, s3, 5
    buffer_load_dwordx4 v[144:147], v7, s[40:43], s22 offen sc1
    v_lshlrev_b32 v7, 4, v0
    s_movk_i32 s20, 16384
    buffer_load_dwordx4 v[152:155], v7, s[36:39], s20 offen sc1
    s_lshl_b32 s20, s3, 2
    s_add_u32 s52, s52, s20
    s_addc_u32 s53, s53, 0
    s_load_dword s34, s[52:53], 0
    s_cmp_lt_u32 s21, 4
    s_cbranch_scc1 KAB_L3
    v_and_b32 v7, 127, v0
    v_lshlrev_b32 v7, 2, v7
    v_bfe_u32 v8, v0, 7, 1
    v_lshl_add_u32 v7, v8, 11, v7
    s_lshl_b32 s20, s30, 9
    s_add_u32 s20, s20, 137216
    buffer_load_dword v216, v7, s[36:39], s20 offen sc1
    s_add_u32 s20, s20, 12288
    buffer_load_dword v217, v7, s[36:39], s20 offen sc1
    s_add_u32 s20, s20, 12288
    buffer_load_dword v218, v7, s[36:39], s20 offen sc1
    s_add_u32 s20, s20, 12288
    buffer_load_dword v219, v7, s[36:39], s20 offen sc1
    s_add_u32 s20, s20, 12288
KAB_L3:
    ds_read_b32 v16, v10 offset:0
    ds_read_b32 v17, v10 offset:3072
    ds_read_b32 v18, v10 offset:6144
    ds_read_b32 v19, v10 offset:9216
    ds_read_b32 v20, v10 offset:1024
    ds_read_b32 v21, v10 offset:4096
    ds_read_b32 v22, v10 offset:7168
    ds_read_b32 v23, v10 offset:10240
    ds_read_b32 v24, v10 offset:2048
    ds_read_b32 v25, v10 offset:5120
    ds_read_b32 v26, v10 offset:8192
    ds_read_b32 v27, v10 offset:11264
    s_waitcnt lgkmcnt(0)
    v_add_f32 v16, v16, v17
    v_add_f32 v18, v18, v19
    v_add_f32 v16, v16, v18
    v_cvt_pk_bf16_f32 v16, v16, v16
    ds_write_b16 v192, v16 offset:16
    v_add_f32 v20, v20, v21
    v_add_f32 v22, v22, v23
    v_add_f32 v20, v20, v22
    v_cvt_pk_bf16_f32 v20, v20, v20
    ds_write_b16 v193, v20 offset:16
    v_add_f32 v24, v24, v25
    v_add_f32 v26, v26, v27
    v_add_f32 v24, v24, v26
    v_cvt_pk_bf16_f32 v24, v24, v24
    ds_write_b16 v194, v24 offset:16
    ds_write_b16 v194, v24 offset:12
    ds_write_b16 v194, v24 offset:14
    ds_write_b16 v194, v24 offset:18
    ds_write_b16 v194, v24 offset:20
    ds_write_b16 v194, v24 offset:22
    v_cmpx_le_u32 vcc, 1, v195
    ds_write_b16 v193, v20 offset:18
    s_mov_b64 exec, -1
    v_cmpx_le_u32 vcc, 2, v195
    ds_write_b16 v193, v20 offset:20
    s_mov_b64 exec, -1
    v_cmpx_le_u32 vcc, 1, v196
    ds_write_b16 v193, v20 offset:14
    s_mov_b64 exec, -1
    v_cmpx_le_u32 vcc, 2, v196
    ds_write_b16 v193, v20 offset:12
    s_mov_b64 exec, -1
    v_cmpx_le_u32 vcc, 4, v197
    ds_write_b16 v194, v24 offset:24
    s_mov_b64 exec, -1
    v_cmpx_le_u32 vcc, 3, v198
    ds_write_b16 v194, v24 offset:10
    s_mov_b64 exec, -1
    v_cmpx_le_u32 vcc, 4, v198
    ds_write_b16 v194, v24 offset:8
    s_mov_b64 exec, -1
    s_cmp_lg_u32 s21, 1
    s_cbranch_scc1 KAB_L4
    v_and_b32 v7, 28, v0
    v_add_u32 v7, 125520, v7
    s_waitcnt vmcnt(2)
    v_mov_b32_dpp v201, v200 quad_perm:[1,1,1,1] row_mask:0xf bank_mask:0xf
    v_mov_b32_dpp v202, v200 quad_perm:[2,2,2,2] row_mask:0xf bank_mask:0xf
    v_mov_b32_dpp v203, v200 quad_perm:[3,3,3,3] row_mask:0xf bank_mask:0xf
    v_mov_b32_dpp v200, v200 quad_perm:[0,0,0,0] row_mask:0xf bank_mask:0xf
    v_add_f32 v200, v200, v201
    v_add_f32 v200, v200, v202
    v_add_f32 v200, v200, v203
    v_cvt_pk_bf16_f32 v200, v200, v200
    v_lshlrev_b32 v200, 16, v200
    ds_write_b32 v7, v200
KAB_L4:
    v_lshl_add_u32 v11, v96, 4, v95
    s_waitcnt lgkmcnt(0)
    s_barrier
    v_lshlrev_b32 v7, 2, v6
    v_add_u32 v7, 125520, v7
    v_mov_b32 v8, 125536
    ds_read_b32 v200, v7
    ds_read_b32 v204, v7 offset:8
    ds_read_b64 v[172:173], v8
    ds_read_b128 v[16:19], v11
    ds_read_b128 v[20:23], v11 offset:16
    v_mul_u32_u24 v9, 33280, v97
    v_lshl_add_u32 v9, v96, 4, v9
    s_waitcnt lgkmcnt(0)
    v_alignbit_b32 v34, v17, v16, 16
    v_alignbit_b32 v35, v18, v17, 16
    v_alignbit_b32 v36, v19, v18, 16
    v_alignbit_b32 v37, v20, v19, 16
    v_alignbit_b32 v38, v21, v20, 16
    v_alignbit_b32 v39, v22, v21, 16
    v_alignbit_b32 v40, v23, v22, 16
    v_mov_b32 v26, v17
    v_mov_b32 v44, v35
    v_mov_b32 v27, v18
    v_mov_b32 v45, v36
    v_mov_b32 v28, v19
    v_mov_b32 v46, v37
    v_mov_b32 v29, v20
    v_mov_b32 v47, v38
    v_mov_b32 v30, v21
    v_mov_b32 v48, v39
    v_mov_b32 v31, v22
    v_mov_b32 v49, v40
    ds_write_b128 v9, v[34:37] offset:48
    ds_write_b128 v9, v[26:29] offset:4208
    ds_write_b128 v9, v[44:47] offset:8368
    ds_write_b128 v9, v[18:21] offset:12528
    ds_write_b128 v9, v[36:39] offset:16688
    ds_write_b128 v9, v[28:31] offset:20848
    ds_write_b128 v9, v[46:49] offset:25008
    ds_write_b128 v9, v[20:23] offset:29168
    s_waitcnt vmcnt(0) lgkmcnt(0)
    v_add_f32 v36, 1.0, v204
    v_cvt_pk_bf16_f32 v36, v36, v36
    v_lshlrev_b32 v36, 16, v36
    v_mov_b32_dpp v156, v152 quad_perm:[1,1,3,3] row_mask:0xf bank_mask:0xf
    v_mov_b32_dpp v157, v153 quad_perm:[1,1,3,3] row_mask:0xf bank_mask:0xf
    v_mov_b32_dpp v158, v154 quad_perm:[1,1,3,3] row_mask:0xf bank_mask:0xf
    v_mov_b32_dpp v159, v155 quad_perm:[1,1,3,3] row_mask:0xf bank_mask:0xf
    v_mov_b32_dpp v152, v152 quad_perm:[0,0,2,2] row_mask:0xf bank_mask:0xf
    v_mov_b32_dpp v153, v153 quad_perm:[0,0,2,2] row_mask:0xf bank_mask:0xf
    v_mov_b32_dpp v154, v154 quad_perm:[0,0,2,2] row_mask:0xf bank_mask:0xf
    v_mov_b32_dpp v155, v155 quad_perm:[0,0,2,2] row_mask:0xf bank_mask:0xf
    v_and_b32 v160, 0xffff0000, v152
    v_lshlrev_b32 v152, 16, v152
    v_and_b32 v161, 0xffff0000, v153
    v_lshlrev_b32 v153, 16, v153
    v_and_b32 v162, 0xffff0000, v154
    v_lshlrev_b32 v154, 16, v154
    v_and_b32 v163, 0xffff0000, v155
    v_lshlrev_b32 v155, 16, v155
    v_and_b32 v164, 0xffff0000, v156
    v_lshlrev_b32 v156, 16, v156
    v_and_b32 v165, 0xffff0000, v157
    v_lshlrev_b32 v157, 16, v157
    v_and_b32 v166, 0xffff0000, v158
    v_lshlrev_b32 v158, 16, v158
    v_and_b32 v167, 0xffff0000, v159
    v_lshlrev_b32 v159, 16, v159
    v_rcp_f32 v160, v160
    v_rcp_f32 v161, v161
    v_rcp_f32 v162, v162
    v_rcp_f32 v163, v163
    v_rcp_f32 v164, v164
    v_rcp_f32 v165, v165
    v_rcp_f32 v166, v166
    v_rcp_f32 v167, v167
    v_mov_b32 v37, s34
    v_lshlrev_b32 v39, 4, v6
    v_lshrrev_b32 v38, v39, v37
    v_lshlrev_b32 v38, 16, v38
    v_lshlrev_b32 v80, 16, v144
    v_and_b32 v81, 0xffff0000, v144
    v_lshlrev_b32 v82, 16, v145
    v_and_b32 v83, 0xffff0000, v145
    v_lshlrev_b32 v84, 16, v146
    v_and_b32 v85, 0xffff0000, v146
    v_lshlrev_b32 v86, 16, v147
    v_and_b32 v87, 0xffff0000, v147
    v_pk_add_f32 v[80:81], v[80:81], v[152:153] neg_lo:[0,1] neg_hi:[0,1]
    v_pk_add_f32 v[82:83], v[82:83], v[154:155] neg_lo:[0,1] neg_hi:[0,1]
    v_pk_add_f32 v[84:85], v[84:85], v[156:157] neg_lo:[0,1] neg_hi:[0,1]
    v_pk_add_f32 v[86:87], v[86:87], v[158:159] neg_lo:[0,1] neg_hi:[0,1]
    v_cvt_pk_bf16_f32 v40, v80, v81
    v_cvt_pk_bf16_f32 v41, v82, v83
    v_cvt_pk_bf16_f32 v42, v84, v85
    v_cvt_pk_bf16_f32 v43, v86, v87
    v_lshlrev_b32 v80, 16, v40
    v_and_b32 v81, 0xffff0000, v40
    v_lshlrev_b32 v82, 16, v41
    v_and_b32 v83, 0xffff0000, v41
    v_lshlrev_b32 v84, 16, v42
    v_and_b32 v85, 0xffff0000, v42
    v_lshlrev_b32 v86, 16, v43
    v_and_b32 v87, 0xffff0000, v43
    v_pk_mul_f32 v[80:81], v[80:81], v[160:161]
    v_pk_mul_f32 v[82:83], v[82:83], v[162:163]
    v_pk_mul_f32 v[84:85], v[84:85], v[164:165]
    v_pk_mul_f32 v[86:87], v[86:87], v[166:167]
    v_cvt_pk_bf16_f32 v40, v80, v81
    v_cvt_pk_bf16_f32 v41, v82, v83
    v_cvt_pk_bf16_f32 v42, v84, v85
    v_cvt_pk_bf16_f32 v43, v86, v87
    v_lshlrev_b32 v80, 16, v40
    v_and_b32 v81, 0xffff0000, v40
    v_lshlrev_b32 v82, 16, v41
    v_and_b32 v83, 0xffff0000, v41
    v_lshlrev_b32 v84, 16, v42
    v_and_b32 v85, 0xffff0000, v42
    v_lshlrev_b32 v86, 16, v43
    v_and_b32 v87, 0xffff0000, v43
    v_mul_f32 v80, v80, v36
    v_mul_f32 v81, v81, v36
    v_mul_f32 v82, v82, v36
    v_mul_f32 v83, v83, v36
    v_mul_f32 v84, v84, v36
    v_mul_f32 v85, v85, v36
    v_mul_f32 v86, v86, v36
    v_mul_f32 v87, v87, v36
    v_cvt_pk_bf16_f32 v40, v80, v81
    v_cvt_pk_bf16_f32 v41, v82, v83
    v_cvt_pk_bf16_f32 v42, v84, v85
    v_cvt_pk_bf16_f32 v43, v86, v87
    v_lshlrev_b32 v80, 16, v40
    v_and_b32 v81, 0xffff0000, v40
    v_lshlrev_b32 v82, 16, v41
    v_and_b32 v83, 0xffff0000, v41
    v_lshlrev_b32 v84, 16, v42
    v_and_b32 v85, 0xffff0000, v42
    v_lshlrev_b32 v86, 16, v43
    v_and_b32 v87, 0xffff0000, v43
    v_add_f32 v80, v200, v80
    v_add_f32 v81, v200, v81
    v_add_f32 v82, v200, v82
    v_add_f32 v83, v200, v83
    v_add_f32 v84, v200, v84
    v_add_f32 v85, v200, v85
    v_add_f32 v86, v200, v86
    v_add_f32 v87, v200, v87
    v_cvt_pk_bf16_f32 v44, v87, v86
    v_cvt_pk_bf16_f32 v45, v85, v84
    v_cvt_pk_bf16_f32 v46, v83, v82
    v_cvt_pk_bf16_f32 v47, v81, v80
    v_lshrrev_b32 v7, 2, v5
    v_mul_u32_u24 v7, 80, v7
    v_and_b32 v8, 3, v5
    v_lshl_add_u32 v7, v8, 4, v7
    v_mul_u32_u24 v8, 7680, v6
    v_add_u32 v7, v7, v8
    v_add_u32 v7, 69120, v7
    ds_write_b128 v7, v[44:47]
    v_lshlrev_b32 v87, 16, v44
    v_and_b32 v86, 0xffff0000, v44
    v_lshlrev_b32 v85, 16, v45
    v_and_b32 v84, 0xffff0000, v45
    v_lshlrev_b32 v83, 16, v46
    v_and_b32 v82, 0xffff0000, v46
    v_lshlrev_b32 v81, 16, v47
    v_and_b32 v80, 0xffff0000, v47
    v_mul_f32 v80, v80, v38
    v_mul_f32 v81, v81, v38
    v_mul_f32 v82, v82, v38
    v_mul_f32 v83, v83, v38
    v_mul_f32 v84, v84, v38
    v_mul_f32 v85, v85, v38
    v_mul_f32 v86, v86, v38
    v_mul_f32 v87, v87, v38
    v_cvt_pk_bf16_f32 v148, v80, v81
    v_cvt_pk_bf16_f32 v149, v82, v83
    v_cvt_pk_bf16_f32 v150, v84, v85
    v_cvt_pk_bf16_f32 v151, v86, v87
    v_lshlrev_b32 v7, 5, v0
    v_add_u32 v7, 129664, v7
    ds_write_b128 v7, v[144:147]
    ds_write_b128 v7, v[148:151] offset:16
    s_cmp_ge_u32 s21, 4
    s_cbranch_scc1 KAB_WP
    s_add_u32 s24, s66, 10485760
    s_addc_u32 s25, s67, 0
    s_mov_b32 s26, 2097152
    s_mov_b32 s27, 0x00020000
    s_lshr_b32 s37, s21, 1
    s_and_b32 s38, s21, 1
    v_and_b32 v7, 3, v0
    v_lshlrev_b32 v8, 6, v0
    v_add_u32 v8, 129664, v8
    v_and_b32 v4, 7, v3
    v_mul_u32_u24 v4, 4160, v4
    v_bfe_u32 v5, v3, 3, 2
    v_lshrrev_b32 v6, 5, v3
    v_sub_u32 v5, v5, v6
    v_lshl_add_u32 v4, v5, 4, v4
    s_mul_i32 s40, s37, 33280
    s_lshl_b32 s41, s38, 10
    s_add_u32 s40, s40, s41
    s_add_u32 s40, s40, 16
    v_add_u32 v4, s40, v4
    v_and_b32 v5, 31, v3
    v_mul_u32_u24 v5, 80, v5
    v_lshl_add_u32 v5, v6, 4, v5
    s_mul_i32 s40, s37, 7680
    s_mul_i32 s41, s38, 1280
    s_sub_u32 s40, s40, s41
    s_add_u32 s40, s40, 67920
    v_add_u32 v5, s40, v5
    s_waitcnt lgkmcnt(0)
    s_barrier
    s_setprio 2
    ds_read_b128 v[144:147], v8 offset:0
    ds_read_b128 v[148:151], v8 offset:16
    ds_read_b128 v[152:155], v8 offset:32
    ds_read_b128 v[156:159], v8 offset:48
    ds_read_b128 v[96:99], v4 offset:32
    ds_read_b128 v[100:103], v4 offset:0
    ds_read_b128 v[104:107], v5 offset:1200
    ds_read_b128 v[108:111], v5 offset:1232
    ds_read_b128 v[112:115], v5 offset:3760
    ds_read_b128 v[116:119], v5 offset:3792
    ds_read_b128 v[120:123], v4 offset:2080
    ds_read_b128 v[124:127], v4 offset:2048
    ds_read_b128 v[176:179], v4 offset:96
    ds_read_b128 v[180:183], v4 offset:64
    ds_read_b128 v[184:187], v5 offset:1120
    ds_read_b128 v[188:191], v5 offset:1152
    ds_read_b128 v[192:195], v5 offset:3680
    ds_read_b128 v[196:199], v5 offset:3712
    ds_read_b128 v[200:203], v4 offset:2144
    ds_read_b128 v[204:207], v4 offset:2112
    s_waitcnt lgkmcnt(12)
    v_mfma_f32_32x32x16_bf16 v[208:223], v[96:99], v[104:107], 0
    v_lshlrev_b32 v64, 16, v144
    v_and_b32 v65, 0xffff0000, v144
    v_mfma_f32_32x32x16_bf16 v[208:223], v[100:103], v[108:111], v[208:223]
    v_lshlrev_b32 v80, 16, v148
    v_and_b32 v81, 0xffff0000, v148
    s_waitcnt lgkmcnt(10)
    v_mfma_f32_32x32x16_bf16 v[224:239], v[96:99], v[112:115], 0
    v_lshlrev_b32 v66, 16, v145
    v_and_b32 v67, 0xffff0000, v145
    v_mfma_f32_32x32x16_bf16 v[224:239], v[100:103], v[116:119], v[224:239]
    v_lshlrev_b32 v82, 16, v149
    v_and_b32 v83, 0xffff0000, v149
    s_waitcnt lgkmcnt(8)
    v_mfma_f32_32x32x16_bf16 v[224:239], v[120:123], v[104:107], v[224:239]
    v_lshlrev_b32 v68, 16, v146
    v_and_b32 v69, 0xffff0000, v146
    v_mfma_f32_32x32x16_bf16 v[224:239], v[124:127], v[108:111], v[224:239]
    v_lshlrev_b32 v84, 16, v150
    v_and_b32 v85, 0xffff0000, v150
    ds_read_b128 v[96:99], v4 offset:160
    ds_read_b128 v[100:103], v4 offset:128
    ds_read_b128 v[104:107], v5 offset:1040
    ds_read_b128 v[108:111], v5 offset:1072
    ds_read_b128 v[112:115], v5 offset:3600
    ds_read_b128 v[116:119], v5 offset:3632
    ds_read_b128 v[120:123], v4 offset:2208
    ds_read_b128 v[124:127], v4 offset:2176
    s_waitcnt lgkmcnt(12)
    v_mfma_f32_32x32x16_bf16 v[208:223], v[176:179], v[184:187], v[208:223]
    v_lshlrev_b32 v70, 16, v147
    v_and_b32 v71, 0xffff0000, v147
    v_mfma_f32_32x32x16_bf16 v[208:223], v[180:183], v[188:191], v[208:223]
    v_lshlrev_b32 v86, 16, v151
    v_and_b32 v87, 0xffff0000, v151
    s_waitcnt lgkmcnt(10)
    v_mfma_f32_32x32x16_bf16 v[224:239], v[176:179], v[192:195], v[224:239]
    v_lshlrev_b32 v72, 16, v152
    v_and_b32 v73, 0xffff0000, v152
    v_mfma_f32_32x32x16_bf16 v[224:239], v[180:183], v[196:199], v[224:239]
    v_lshlrev_b32 v88, 16, v156
    v_and_b32 v89, 0xffff0000, v156
    s_waitcnt lgkmcnt(8)
    v_mfma_f32_32x32x16_bf16 v[224:239], v[200:203], v[184:187], v[224:239]
    v_lshlrev_b32 v74, 16, v153
    v_and_b32 v75, 0xffff0000, v153
    v_mfma_f32_32x32x16_bf16 v[224:239], v[204:207], v[188:191], v[224:239]
    v_lshlrev_b32 v90, 16, v157
    v_and_b32 v91, 0xffff0000, v157
    ds_read_b128 v[176:179], v4 offset:224
    ds_read_b128 v[180:183], v4 offset:192
    ds_read_b128 v[184:187], v5 offset:960
    ds_read_b128 v[188:191], v5 offset:992
    ds_read_b128 v[192:195], v5 offset:3520
    ds_read_b128 v[196:199], v5 offset:3552
    ds_read_b128 v[200:203], v4 offset:2272
    ds_read_b128 v[204:207], v4 offset:2240
    s_waitcnt lgkmcnt(12)
    v_mfma_f32_32x32x16_bf16 v[208:223], v[96:99], v[104:107], v[208:223]
    v_lshlrev_b32 v76, 16, v154
    v_and_b32 v77, 0xffff0000, v154
    v_mfma_f32_32x32x16_bf16 v[208:223], v[100:103], v[108:111], v[208:223]
    v_lshlrev_b32 v92, 16, v158
    v_and_b32 v93, 0xffff0000, v158
    s_waitcnt lgkmcnt(10)
    v_mfma_f32_32x32x16_bf16 v[224:239], v[96:99], v[112:115], v[224:239]
    v_lshlrev_b32 v78, 16, v155
    v_and_b32 v79, 0xffff0000, v155
    v_mfma_f32_32x32x16_bf16 v[224:239], v[100:103], v[116:119], v[224:239]
    v_lshlrev_b32 v94, 16, v159
    v_and_b32 v95, 0xffff0000, v159
    s_waitcnt lgkmcnt(8)
    v_mfma_f32_32x32x16_bf16 v[224:239], v[120:123], v[104:107], v[224:239]
    v_mfma_f32_32x32x16_bf16 v[224:239], v[124:127], v[108:111], v[224:239]
    ds_read_b128 v[96:99], v4 offset:288
    ds_read_b128 v[100:103], v4 offset:256
    ds_read_b128 v[104:107], v5 offset:880
    ds_read_b128 v[108:111], v5 offset:912
    ds_read_b128 v[112:115], v5 offset:3440
    ds_read_b128 v[116:119], v5 offset:3472
    ds_read_b128 v[120:123], v4 offset:2336
    ds_read_b128 v[124:127], v4 offset:2304
    s_waitcnt lgkmcnt(12)
    v_mfma_f32_32x32x16_bf16 v[208:223], v[176:179], v[184:187], v[208:223]
    v_mfma_f32_32x32x16_bf16 v[208:223], v[180:183], v[188:191], v[208:223]
    s_waitcnt lgkmcnt(10)
    v_mfma_f32_32x32x16_bf16 v[224:239], v[176:179], v[192:195], v[224:239]
    v_mfma_f32_32x32x16_bf16 v[224:239], v[180:183], v[196:199], v[224:239]
    s_waitcnt lgkmcnt(8)
    v_mfma_f32_32x32x16_bf16 v[224:239], v[200:203], v[184:187], v[224:239]
    v_mfma_f32_32x32x16_bf16 v[224:239], v[204:207], v[188:191], v[224:239]
    ds_read_b128 v[176:179], v4 offset:352
    ds_read_b128 v[180:183], v4 offset:320
    ds_read_b128 v[184:187], v5 offset:800
    ds_read_b128 v[188:191], v5 offset:832
    ds_read_b128 v[192:195], v5 offset:3360
    ds_read_b128 v[196:199], v5 offset:3392
    ds_read_b128 v[200:203], v4 offset:2400
    ds_read_b128 v[204:207], v4 offset:2368
    s_waitcnt lgkmcnt(12)
    v_mfma_f32_32x32x16_bf16 v[208:223], v[96:99], v[104:107], v[208:223]
    v_mfma_f32_32x32x16_bf16 v[208:223], v[100:103], v[108:111], v[208:223]
    s_waitcnt lgkmcnt(10)
    v_mfma_f32_32x32x16_bf16 v[224:239], v[96:99], v[112:115], v[224:239]
    v_mfma_f32_32x32x16_bf16 v[224:239], v[100:103], v[116:119], v[224:239]
    s_waitcnt lgkmcnt(8)
    v_mfma_f32_32x32x16_bf16 v[224:239], v[120:123], v[104:107], v[224:239]
    v_mfma_f32_32x32x16_bf16 v[224:239], v[124:127], v[108:111], v[224:239]
    ds_read_b128 v[96:99], v4 offset:416
    ds_read_b128 v[100:103], v4 offset:384
    ds_read_b128 v[104:107], v5 offset:720
    ds_read_b128 v[108:111], v5 offset:752
    ds_read_b128 v[112:115], v5 offset:3280
    ds_read_b128 v[116:119], v5 offset:3312
    ds_read_b128 v[120:123], v4 offset:2464
    ds_read_b128 v[124:127], v4 offset:2432
    s_waitcnt lgkmcnt(12)
    v_mfma_f32_32x32x16_bf16 v[208:223], v[176:179], v[184:187], v[208:223]
    v_mfma_f32_32x32x16_bf16 v[208:223], v[180:183], v[188:191], v[208:223]
    s_waitcnt lgkmcnt(10)
    v_mfma_f32_32x32x16_bf16 v[224:239], v[176:179], v[192:195], v[224:239]
    v_mfma_f32_32x32x16_bf16 v[224:239], v[180:183], v[196:199], v[224:239]
    s_waitcnt lgkmcnt(8)
    v_mfma_f32_32x32x16_bf16 v[224:239], v[200:203], v[184:187], v[224:239]
    v_mfma_f32_32x32x16_bf16 v[224:239], v[204:207], v[188:191], v[224:239]
    ds_read_b128 v[176:179], v4 offset:480
    ds_read_b128 v[180:183], v4 offset:448
    ds_read_b128 v[184:187], v5 offset:640
    ds_read_b128 v[188:191], v5 offset:672
    ds_read_b128 v[192:195], v5 offset:3200
    ds_read_b128 v[196:199], v5 offset:3232
    ds_read_b128 v[200:203], v4 offset:2528
    ds_read_b128 v[204:207], v4 offset:2496
    s_waitcnt lgkmcnt(12)
    v_mfma_f32_32x32x16_bf16 v[208:223], v[96:99], v[104:107], v[208:223]
    v_mfma_f32_32x32x16_bf16 v[208:223], v[100:103], v[108:111], v[208:223]
    s_waitcnt lgkmcnt(10)
    v_mfma_f32_32x32x16_bf16 v[224:239], v[96:99], v[112:115], v[224:239]
    v_mfma_f32_32x32x16_bf16 v[224:239], v[100:103], v[116:119], v[224:239]
    s_waitcnt lgkmcnt(8)
    v_mfma_f32_32x32x16_bf16 v[224:239], v[120:123], v[104:107], v[224:239]
    v_mfma_f32_32x32x16_bf16 v[224:239], v[124:127], v[108:111], v[224:239]
    ds_read_b128 v[96:99], v4 offset:544
    ds_read_b128 v[100:103], v4 offset:512
    ds_read_b128 v[104:107], v5 offset:560
    ds_read_b128 v[108:111], v5 offset:592
    ds_read_b128 v[112:115], v5 offset:3120
    ds_read_b128 v[116:119], v5 offset:3152
    ds_read_b128 v[120:123], v4 offset:2592
    ds_read_b128 v[124:127], v4 offset:2560
    s_waitcnt lgkmcnt(12)
    v_mfma_f32_32x32x16_bf16 v[208:223], v[176:179], v[184:187], v[208:223]
    v_mfma_f32_32x32x16_bf16 v[208:223], v[180:183], v[188:191], v[208:223]
    s_waitcnt lgkmcnt(10)
    v_mfma_f32_32x32x16_bf16 v[224:239], v[176:179], v[192:195], v[224:239]
    v_mfma_f32_32x32x16_bf16 v[224:239], v[180:183], v[196:199], v[224:239]
    s_waitcnt lgkmcnt(8)
    v_mfma_f32_32x32x16_bf16 v[224:239], v[200:203], v[184:187], v[224:239]
    v_mfma_f32_32x32x16_bf16 v[224:239], v[204:207], v[188:191], v[224:239]
    ds_read_b128 v[176:179], v4 offset:608
    ds_read_b128 v[180:183], v4 offset:576
    ds_read_b128 v[184:187], v5 offset:480
    ds_read_b128 v[188:191], v5 offset:512
    ds_read_b128 v[192:195], v5 offset:3040
    ds_read_b128 v[196:199], v5 offset:3072
    ds_read_b128 v[200:203], v4 offset:2656
    ds_read_b128 v[204:207], v4 offset:2624
    s_waitcnt lgkmcnt(12)
    v_mfma_f32_32x32x16_bf16 v[208:223], v[96:99], v[104:107], v[208:223]
    v_mfma_f32_32x32x16_bf16 v[208:223], v[100:103], v[108:111], v[208:223]
    s_waitcnt lgkmcnt(10)
    v_mfma_f32_32x32x16_bf16 v[224:239], v[96:99], v[112:115], v[224:239]
    v_mfma_f32_32x32x16_bf16 v[224:239], v[100:103], v[116:119], v[224:239]
    s_waitcnt lgkmcnt(8)
    v_mfma_f32_32x32x16_bf16 v[224:239], v[120:123], v[104:107], v[224:239]
    v_mfma_f32_32x32x16_bf16 v[224:239], v[124:127], v[108:111], v[224:239]
    ds_read_b128 v[96:99], v4 offset:672
    ds_read_b128 v[100:103], v4 offset:640
    ds_read_b128 v[104:107], v5 offset:400
    ds_read_b128 v[108:111], v5 offset:432
    ds_read_b128 v[112:115], v5 offset:2960
    ds_read_b128 v[116:119], v5 offset:2992
    ds_read_b128 v[120:123], v4 offset:2720
    ds_read_b128 v[124:127], v4 offset:2688
    s_waitcnt lgkmcnt(12)
    v_mfma_f32_32x32x16_bf16 v[208:223], v[176:179], v[184:187], v[208:223]
    v_mfma_f32_32x32x16_bf16 v[208:223], v[180:183], v[188:191], v[208:223]
    s_waitcnt lgkmcnt(10)
    v_mfma_f32_32x32x16_bf16 v[224:239], v[176:179], v[192:195], v[224:239]
    v_mfma_f32_32x32x16_bf16 v[224:239], v[180:183], v[196:199], v[224:239]
    s_waitcnt lgkmcnt(8)
    v_mfma_f32_32x32x16_bf16 v[224:239], v[200:203], v[184:187], v[224:239]
    v_mfma_f32_32x32x16_bf16 v[224:239], v[204:207], v[188:191], v[224:239]
    ds_read_b128 v[176:179], v4 offset:736
    ds_read_b128 v[180:183], v4 offset:704
    ds_read_b128 v[184:187], v5 offset:320
    ds_read_b128 v[188:191], v5 offset:352
    ds_read_b128 v[192:195], v5 offset:2880
    ds_read_b128 v[196:199], v5 offset:2912
    ds_read_b128 v[200:203], v4 offset:2784
    ds_read_b128 v[204:207], v4 offset:2752
    s_waitcnt lgkmcnt(12)
    v_mfma_f32_32x32x16_bf16 v[208:223], v[96:99], v[104:107], v[208:223]
    v_mfma_f32_32x32x16_bf16 v[208:223], v[100:103], v[108:111], v[208:223]
    s_waitcnt lgkmcnt(10)
    v_mfma_f32_32x32x16_bf16 v[224:239], v[96:99], v[112:115], v[224:239]
    v_mfma_f32_32x32x16_bf16 v[224:239], v[100:103], v[116:119], v[224:239]
    s_waitcnt lgkmcnt(8)
    v_mfma_f32_32x32x16_bf16 v[224:239], v[120:123], v[104:107], v[224:239]
    v_mfma_f32_32x32x16_bf16 v[224:239], v[124:127], v[108:111], v[224:239]
    ds_read_b128 v[96:99], v4 offset:800
    ds_read_b128 v[100:103], v4 offset:768
    ds_read_b128 v[104:107], v5 offset:240
    ds_read_b128 v[108:111], v5 offset:272
    ds_read_b128 v[112:115], v5 offset:2800
    ds_read_b128 v[116:119], v5 offset:2832
    ds_read_b128 v[120:123], v4 offset:2848
    ds_read_b128 v[124:127], v4 offset:2816
    s_waitcnt lgkmcnt(12)
    v_mfma_f32_32x32x16_bf16 v[208:223], v[176:179], v[184:187], v[208:223]
    v_mfma_f32_32x32x16_bf16 v[208:223], v[180:183], v[188:191], v[208:223]
    s_waitcnt lgkmcnt(10)
    v_mfma_f32_32x32x16_bf16 v[224:239], v[176:179], v[192:195], v[224:239]
    v_mfma_f32_32x32x16_bf16 v[224:239], v[180:183], v[196:199], v[224:239]
    s_waitcnt lgkmcnt(8)
    v_mfma_f32_32x32x16_bf16 v[224:239], v[200:203], v[184:187], v[224:239]
    v_mfma_f32_32x32x16_bf16 v[224:239], v[204:207], v[188:191], v[224:239]
    ds_read_b128 v[176:179], v4 offset:864
    ds_read_b128 v[180:183], v4 offset:832
    ds_read_b128 v[184:187], v5 offset:160
    ds_read_b128 v[188:191], v5 offset:192
    ds_read_b128 v[192:195], v5 offset:2720
    ds_read_b128 v[196:199], v5 offset:2752
    ds_read_b128 v[200:203], v4 offset:2912
    ds_read_b128 v[204:207], v4 offset:2880
    s_waitcnt lgkmcnt(12)
    v_mfma_f32_32x32x16_bf16 v[208:223], v[96:99], v[104:107], v[208:223]
    v_mfma_f32_32x32x16_bf16 v[208:223], v[100:103], v[108:111], v[208:223]
    s_waitcnt lgkmcnt(10)
    v_mfma_f32_32x32x16_bf16 v[224:239], v[96:99], v[112:115], v[224:239]
    v_mfma_f32_32x32x16_bf16 v[224:239], v[100:103], v[116:119], v[224:239]
    s_waitcnt lgkmcnt(8)
    v_mfma_f32_32x32x16_bf16 v[224:239], v[120:123], v[104:107], v[224:239]
    v_mfma_f32_32x32x16_bf16 v[224:239], v[124:127], v[108:111], v[224:239]
    ds_read_b128 v[96:99], v4 offset:928
    ds_read_b128 v[100:103], v4 offset:896
    ds_read_b128 v[104:107], v5 offset:80
    ds_read_b128 v[108:111], v5 offset:112
    ds_read_b128 v[112:115], v5 offset:2640
    ds_read_b128 v[116:119], v5 offset:2672
    ds_read_b128 v[120:123], v4 offset:2976
    ds_read_b128 v[124:127], v4 offset:2944
    s_waitcnt lgkmcnt(12)
    v_mfma_f32_32x32x16_bf16 v[208:223], v[176:179], v[184:187], v[208:223]
    v_mfma_f32_32x32x16_bf16 v[208:223], v[180:183], v[188:191], v[208:223]
    s_waitcnt lgkmcnt(10)
    v_mfma_f32_32x32x16_bf16 v[224:239], v[176:179], v[192:195], v[224:239]
    v_mfma_f32_32x32x16_bf16 v[224:239], v[180:183], v[196:199], v[224:239]
    s_waitcnt lgkmcnt(8)
    v_mfma_f32_32x32x16_bf16 v[224:239], v[200:203], v[184:187], v[224:239]
    v_mfma_f32_32x32x16_bf16 v[224:239], v[204:207], v[188:191], v[224:239]
    ds_read_b128 v[176:179], v4 offset:992
    ds_read_b128 v[180:183], v4 offset:960
    ds_read_b128 v[184:187], v5 offset:0
    ds_read_b128 v[188:191], v5 offset:32
    ds_read_b128 v[192:195], v5 offset:2560
    ds_read_b128 v[196:199], v5 offset:2592
    ds_read_b128 v[200:203], v4 offset:3040
    ds_read_b128 v[204:207], v4 offset:3008
    s_waitcnt lgkmcnt(12)
    v_mfma_f32_32x32x16_bf16 v[208:223], v[96:99], v[104:107], v[208:223]
    v_mfma_f32_32x32x16_bf16 v[208:223], v[100:103], v[108:111], v[208:223]
    s_waitcnt lgkmcnt(10)
    v_mfma_f32_32x32x16_bf16 v[224:239], v[96:99], v[112:115], v[224:239]
    v_mfma_f32_32x32x16_bf16 v[224:239], v[100:103], v[116:119], v[224:239]
    s_waitcnt lgkmcnt(8)
    v_mfma_f32_32x32x16_bf16 v[224:239], v[120:123], v[104:107], v[224:239]
    v_mfma_f32_32x32x16_bf16 v[224:239], v[124:127], v[108:111], v[224:239]
    s_waitcnt lgkmcnt(4)
    v_mfma_f32_32x32x16_bf16 v[208:223], v[176:179], v[184:187], v[208:223]
    v_mfma_f32_32x32x16_bf16 v[208:223], v[180:183], v[188:191], v[208:223]
    s_waitcnt lgkmcnt(2)
    v_mfma_f32_32x32x16_bf16 v[224:239], v[176:179], v[192:195], v[224:239]
    v_mfma_f32_32x32x16_bf16 v[224:239], v[180:183], v[196:199], v[224:239]
    s_waitcnt lgkmcnt(0)
    v_mfma_f32_32x32x16_bf16 v[224:239], v[200:203], v[184:187], v[224:239]
    v_mfma_f32_32x32x16_bf16 v[224:239], v[204:207], v[188:191], v[224:239]
    v_and_b32 v4, 31, v3
    v_mul_u32_u24 v4, 144, v4
    v_lshl_add_u32 v4, v6, 4, v4
    s_mul_i32 s40, s21, 9216
    s_add_u32 s40, s40, 81920
    v_add_u32 v4, s40, v4
    v_lshrrev_b32 v5, 2, v0
    v_mul_u32_u24 v5, 144, v5
    v_lshl_add_u32 v5, v7, 5, v5
    v_add_u32 v5, 81920, v5
    s_nop 3
    ds_write_b128 v4, v[208:211] offset:0
    ds_write_b128 v4, v[212:215] offset:32
    ds_write_b128 v4, v[216:219] offset:64
    ds_write_b128 v4, v[220:223] offset:96
    ds_write_b128 v4, v[224:227] offset:4608
    ds_write_b128 v4, v[228:231] offset:4640
    ds_write_b128 v4, v[232:235] offset:4672
    ds_write_b128 v4, v[236:239] offset:4704
    v_lshrrev_b32 v4, 5, v0
    v_lshlrev_b32 v4, 18, v4
    v_and_b32 v6, 31, v0
    v_lshl_add_u32 v4, v6, 4, v4
    s_lshr_b32 s40, s3, 2
    s_lshl_b32 s40, s40, 9
    s_and_b32 s41, s3, 3
    s_lshl_b32 s41, s41, 2
    s_add_u32 s40, s40, s41
    s_waitcnt lgkmcnt(0)
    s_barrier
    ds_read_b128 v[96:99], v5 offset:0
    ds_read_b128 v[100:103], v5 offset:16
    ds_read_b128 v[104:107], v5 offset:9216
    ds_read_b128 v[108:111], v5 offset:9232
    ds_read_b128 v[112:115], v5 offset:18432
    ds_read_b128 v[116:119], v5 offset:18448
    ds_read_b128 v[120:123], v5 offset:27648
    ds_read_b128 v[124:127], v5 offset:27664
    s_waitcnt lgkmcnt(4)
    v_pk_add_f32 v[96:97], v[96:97], v[104:105]
    v_pk_add_f32 v[98:99], v[98:99], v[106:107]
    v_pk_add_f32 v[100:101], v[100:101], v[108:109]
    v_pk_add_f32 v[102:103], v[102:103], v[110:111]
    v_cvt_pk_bf16_f32 v40, v96, v97
    v_cvt_pk_bf16_f32 v41, v98, v99
    v_cvt_pk_bf16_f32 v42, v100, v101
    v_cvt_pk_bf16_f32 v43, v102, v103
    v_lshlrev_b32 v96, 16, v40
    v_and_b32 v97, 0xffff0000, v40
    v_lshlrev_b32 v98, 16, v41
    v_and_b32 v99, 0xffff0000, v41
    v_lshlrev_b32 v100, 16, v42
    v_and_b32 v101, 0xffff0000, v42
    v_lshlrev_b32 v102, 16, v43
    v_and_b32 v103, 0xffff0000, v43
    v_pk_add_f32 v[96:97], v[96:97], v[80:81]
    v_pk_add_f32 v[98:99], v[98:99], v[82:83]
    v_pk_add_f32 v[100:101], v[100:101], v[84:85]
    v_pk_add_f32 v[102:103], v[102:103], v[86:87]
    v_cvt_pk_bf16_f32 v40, v96, v97
    v_cvt_pk_bf16_f32 v41, v98, v99
    v_cvt_pk_bf16_f32 v42, v100, v101
    v_cvt_pk_bf16_f32 v43, v102, v103
    v_lshlrev_b32 v96, 16, v40
    v_and_b32 v97, 0xffff0000, v40
    v_lshlrev_b32 v98, 16, v41
    v_and_b32 v99, 0xffff0000, v41
    v_lshlrev_b32 v100, 16, v42
    v_and_b32 v101, 0xffff0000, v42
    v_lshlrev_b32 v102, 16, v43
    v_and_b32 v103, 0xffff0000, v43
    v_mul_f32 v96, v172, v96
    v_mul_f32 v97, v172, v97
    v_mul_f32 v98, v172, v98
    v_mul_f32 v99, v172, v99
    v_mul_f32 v100, v172, v100
    v_mul_f32 v101, v172, v101
    v_mul_f32 v102, v172, v102
    v_mul_f32 v103, v172, v103
    v_cvt_pk_bf16_f32 v40, v96, v97
    v_cvt_pk_bf16_f32 v41, v98, v99
    v_cvt_pk_bf16_f32 v42, v100, v101
    v_cvt_pk_bf16_f32 v43, v102, v103
    v_lshlrev_b32 v96, 16, v40
    v_and_b32 v97, 0xffff0000, v40
    v_lshlrev_b32 v98, 16, v41
    v_and_b32 v99, 0xffff0000, v41
    v_lshlrev_b32 v100, 16, v42
    v_and_b32 v101, 0xffff0000, v42
    v_lshlrev_b32 v102, 16, v43
    v_and_b32 v103, 0xffff0000, v43
    v_pk_add_f32 v[96:97], v[96:97], v[64:65]
    v_pk_add_f32 v[98:99], v[98:99], v[66:67]
    v_pk_add_f32 v[100:101], v[100:101], v[68:69]
    v_pk_add_f32 v[102:103], v[102:103], v[70:71]
    s_waitcnt lgkmcnt(0)
    v_pk_add_f32 v[112:113], v[112:113], v[120:121]
    v_pk_add_f32 v[114:115], v[114:115], v[122:123]
    v_pk_add_f32 v[116:117], v[116:117], v[124:125]
    v_pk_add_f32 v[118:119], v[118:119], v[126:127]
    v_cvt_pk_bf16_f32 v40, v112, v113
    v_cvt_pk_bf16_f32 v41, v114, v115
    v_cvt_pk_bf16_f32 v42, v116, v117
    v_cvt_pk_bf16_f32 v43, v118, v119
    v_lshlrev_b32 v112, 16, v40
    v_and_b32 v113, 0xffff0000, v40
    v_lshlrev_b32 v114, 16, v41
    v_and_b32 v115, 0xffff0000, v41
    v_lshlrev_b32 v116, 16, v42
    v_and_b32 v117, 0xffff0000, v42
    v_lshlrev_b32 v118, 16, v43
    v_and_b32 v119, 0xffff0000, v43
    v_pk_add_f32 v[112:113], v[112:113], v[88:89]
    v_pk_add_f32 v[114:115], v[114:115], v[90:91]
    v_pk_add_f32 v[116:117], v[116:117], v[92:93]
    v_pk_add_f32 v[118:119], v[118:119], v[94:95]
    v_cvt_pk_bf16_f32 v40, v112, v113
    v_cvt_pk_bf16_f32 v41, v114, v115
    v_cvt_pk_bf16_f32 v42, v116, v117
    v_cvt_pk_bf16_f32 v43, v118, v119
    v_lshlrev_b32 v112, 16, v40
    v_and_b32 v113, 0xffff0000, v40
    v_lshlrev_b32 v114, 16, v41
    v_and_b32 v115, 0xffff0000, v41
    v_lshlrev_b32 v116, 16, v42
    v_and_b32 v117, 0xffff0000, v42
    v_lshlrev_b32 v118, 16, v43
    v_and_b32 v119, 0xffff0000, v43
    v_mul_f32 v112, v173, v112
    v_mul_f32 v113, v173, v113
    v_mul_f32 v114, v173, v114
    v_mul_f32 v115, v173, v115
    v_mul_f32 v116, v173, v116
    v_mul_f32 v117, v173, v117
    v_mul_f32 v118, v173, v118
    v_mul_f32 v119, v173, v119
    v_cvt_pk_bf16_f32 v40, v112, v113
    v_cvt_pk_bf16_f32 v41, v114, v115
    v_cvt_pk_bf16_f32 v42, v116, v117
    v_cvt_pk_bf16_f32 v43, v118, v119
    v_lshlrev_b32 v112, 16, v40
    v_and_b32 v113, 0xffff0000, v40
    v_lshlrev_b32 v114, 16, v41
    v_and_b32 v115, 0xffff0000, v41
    v_lshlrev_b32 v116, 16, v42
    v_and_b32 v117, 0xffff0000, v42
    v_lshlrev_b32 v118, 16, v43
    v_and_b32 v119, 0xffff0000, v43
    v_pk_add_f32 v[112:113], v[112:113], v[72:73]
    v_pk_add_f32 v[114:115], v[114:115], v[74:75]
    v_pk_add_f32 v[116:117], v[116:117], v[76:77]
    v_pk_add_f32 v[118:119], v[118:119], v[78:79]
    v_cvt_pk_bf16_f32 v128, v96, v112
    s_add_u32 s41, s40, 0
    buffer_store_dword v128, v4, s[24:27], s41 offen
    v_cvt_pk_bf16_f32 v129, v97, v113
    s_add_u32 s41, s40, 32768
    buffer_store_dword v129, v4, s[24:27], s41 offen
    v_cvt_pk_bf16_f32 v130, v98, v114
    s_add_u32 s41, s40, 65536
    buffer_store_dword v130, v4, s[24:27], s41 offen
    v_cvt_pk_bf16_f32 v131, v99, v115
    s_add_u32 s41, s40, 98304
    buffer_store_dword v131, v4, s[24:27], s41 offen
    v_cvt_pk_bf16_f32 v132, v100, v116
    s_add_u32 s41, s40, 131072
    buffer_store_dword v132, v4, s[24:27], s41 offen
    v_cvt_pk_bf16_f32 v133, v101, v117
    s_add_u32 s41, s40, 163840
    buffer_store_dword v133, v4, s[24:27], s41 offen
    v_cvt_pk_bf16_f32 v134, v102, v118
    s_add_u32 s41, s40, 196608
    buffer_store_dword v134, v4, s[24:27], s41 offen
    v_cvt_pk_bf16_f32 v135, v103, v119
    s_add_u32 s41, s40, 229376
    buffer_store_dword v135, v4, s[24:27], s41 offen
    s_endpgm
KAB_WP:
    s_cmp_ge_u32 s2, 224
    s_cbranch_scc0 KAB_WP1
    s_waitcnt lgkmcnt(0)
    s_barrier
    s_add_u32 s12, s66, 17825792
    s_addc_u32 s13, s67, 0
    s_mov_b32 s14, 1835008
    s_mov_b32 s15, 0x00020000
    v_lshrrev_b32 v5, 4, v96
    s_mov_b32 s20, 114688
    v_mul_lo_u32 v6, v5, s20
    v_bfe_u32 v7, v96, 3, 1
    v_lshl_add_u32 v6, v7, 8, v6
    v_bfe_u32 v7, v96, 1, 1
    v_lshl_add_u32 v6, v7, 7, v6
    v_bfe_u32 v7, v96, 2, 1
    v_lshl_add_u32 v6, v7, 6, v6
    v_and_b32 v7, 1, v96
    v_lshl_add_u32 v6, v7, 5, v6
    s_mul_i32 s20, s31, 3584
    s_mov_b32 s22, 0x05040100
    s_mov_b32 s23, 0x07060302
    v_perm_b32 v16, v117, v116, s22
    v_perm_b32 v20, v117, v116, s23
    v_perm_b32 v17, v119, v118, s22
    v_perm_b32 v21, v119, v118, s23
    v_perm_b32 v18, v121, v120, s22
    v_perm_b32 v22, v121, v120, s23
    v_perm_b32 v19, v123, v122, s22
    v_perm_b32 v23, v123, v122, s23
    buffer_store_dwordx4 v[16:19], v6, s[12:15], s20 offen offset:0
    buffer_store_dwordx4 v[20:23], v6, s[12:15], s20 offen offset:16
    v_perm_b32 v24, v125, v124, s22
    v_perm_b32 v28, v125, v124, s23
    v_perm_b32 v25, v127, v126, s22
    v_perm_b32 v29, v127, v126, s23
    v_perm_b32 v26, v129, v128, s22
    v_perm_b32 v30, v129, v128, s23
    v_perm_b32 v27, v131, v130, s22
    v_perm_b32 v31, v131, v130, s23
    buffer_store_dwordx4 v[24:27], v6, s[12:15], s20 offen offset:512
    buffer_store_dwordx4 v[28:31], v6, s[12:15], s20 offen offset:528
    v_perm_b32 v32, v221, v220, s22
    v_perm_b32 v36, v221, v220, s23
    v_perm_b32 v33, v223, v222, s22
    v_perm_b32 v37, v223, v222, s23
    v_perm_b32 v34, v225, v224, s22
    v_perm_b32 v38, v225, v224, s23
    v_perm_b32 v35, v227, v226, s22
    v_perm_b32 v39, v227, v226, s23
    buffer_store_dwordx4 v[32:35], v6, s[12:15], s20 offen offset:1024
    buffer_store_dwordx4 v[36:39], v6, s[12:15], s20 offen offset:1040
    v_perm_b32 v40, v229, v228, s22
    v_perm_b32 v44, v229, v228, s23
    v_perm_b32 v41, v231, v230, s22
    v_perm_b32 v45, v231, v230, s23
    v_perm_b32 v42, v233, v232, s22
    v_perm_b32 v46, v233, v232, s23
    v_perm_b32 v43, v235, v234, s22
    v_perm_b32 v47, v235, v234, s23
    buffer_store_dwordx4 v[40:43], v6, s[12:15], s20 offen offset:1536
    buffer_store_dwordx4 v[44:47], v6, s[12:15], s20 offen offset:1552
    v_perm_b32 v48, v237, v236, s22
    v_perm_b32 v52, v237, v236, s23
    v_perm_b32 v49, v239, v238, s22
    v_perm_b32 v53, v239, v238, s23
    v_perm_b32 v50, v241, v240, s22
    v_perm_b32 v54, v241, v240, s23
    v_perm_b32 v51, v243, v242, s22
    v_perm_b32 v55, v243, v242, s23
    buffer_store_dwordx4 v[48:51], v6, s[12:15], s20 offen offset:2048
    buffer_store_dwordx4 v[52:55], v6, s[12:15], s20 offen offset:2064
    v_perm_b32 v56, v245, v244, s22
    v_perm_b32 v60, v245, v244, s23
    v_perm_b32 v57, v247, v246, s22
    v_perm_b32 v61, v247, v246, s23
    v_perm_b32 v58, v249, v248, s22
    v_perm_b32 v62, v249, v248, s23
    v_perm_b32 v59, v251, v250, s22
    v_perm_b32 v63, v251, v250, s23
    buffer_store_dwordx4 v[56:59], v6, s[12:15], s20 offen offset:2560
    buffer_store_dwordx4 v[60:63], v6, s[12:15], s20 offen offset:2576
    v_perm_b32 v64, v177, v176, s22
    v_perm_b32 v68, v177, v176, s23
    v_perm_b32 v65, v179, v178, s22
    v_perm_b32 v69, v179, v178, s23
    v_perm_b32 v66, v181, v180, s22
    v_perm_b32 v70, v181, v180, s23
    v_perm_b32 v67, v183, v182, s22
    v_perm_b32 v71, v183, v182, s23
    buffer_store_dwordx4 v[64:67], v6, s[12:15], s20 offen offset:3072
    buffer_store_dwordx4 v[68:71], v6, s[12:15], s20 offen offset:3088
    s_endpgm
KAB_WP1:
    s_add_u32 s12, s66, 12582912
    s_addc_u32 s13, s67, 0
    s_mov_b32 s14, 3670016
    s_mov_b32 s15, 0x00020000
    s_add_u32 s24, s66, 262144
    s_addc_u32 s25, s67, 0
    s_mov_b32 s26, 131072
    s_mov_b32 s27, 0x00020000
    v_add_f32 v216, v216, v217
    v_add_f32 v216, v216, v218
    v_add_f32 v216, v216, v219
    v_cvt_pk_bf16_f32 v216, v216, v216
    v_lshlrev_b32 v216, 16, v216
    v_lshlrev_b32 v7, 2, v96
    v_add_u32 v7, 146048, v7
    ds_write_b32 v7, v216
    v_and_b32 v6, 7, v114
    v_lshlrev_b32 v6, 6, v6
    v_add_u32 v6, 146048, v6
    s_waitcnt lgkmcnt(0)
    s_barrier
    ds_read_b128 v[144:147], v6 offset:0
    ds_read_b128 v[160:163], v6 offset:512
    ds_read_b128 v[148:151], v6 offset:16
    ds_read_b128 v[164:167], v6 offset:528
    ds_read_b128 v[152:155], v6 offset:32
    ds_read_b128 v[168:171], v6 offset:544
    ds_read_b128 v[156:159], v6 offset:48
    ds_read_b128 v[172:175], v6 offset:560
    s_cmp_ge_u32 s2, 224
    s_cselect_b32 s14, 0, s14
    s_cselect_b32 s26, 0, s26
    v_lshlrev_b32 v6, 10, v114
    v_lshrrev_b32 v7, 3, v113
    v_lshl_add_u32 v6, v7, 15, v6
    v_bfe_u32 v7, v113, 1, 1
    v_lshl_add_u32 v6, v7, 8, v6
    v_bfe_u32 v8, v113, 2, 1
    v_lshl_add_u32 v6, v8, 6, v6
    v_and_b32 v9, 1, v113
    v_lshl_add_u32 v6, v9, 5, v6
    s_lshl_b32 s29, s31, 17
    s_and_b32 s23, s2, 1
    s_lshl_b32 s28, s23, 7
    s_add_u32 s29, s29, s28
    s_waitcnt lgkmcnt(0)
    v_mov_b32 v10, 0x3f803f80
    v_mov_b32 v16, 0
    v_mov_b32 v17, 0
    v_mov_b32 v18, 0
    v_mov_b32 v19, 0
    v_add_f32 v160, 1.0, v160
    v_add_f32 v161, 1.0, v161
    v_add_f32 v162, 1.0, v162
    v_add_f32 v163, 1.0, v163
    v_add_f32 v164, 1.0, v164
    v_add_f32 v165, 1.0, v165
    v_add_f32 v166, 1.0, v166
    v_add_f32 v167, 1.0, v167
    v_add_f32 v168, 1.0, v168
    v_add_f32 v169, 1.0, v169
    v_add_f32 v170, 1.0, v170
    v_add_f32 v171, 1.0, v171
    v_add_f32 v172, 1.0, v172
    v_add_f32 v173, 1.0, v173
    v_add_f32 v174, 1.0, v174
    v_add_f32 v175, 1.0, v175
    v_cvt_pk_bf16_f32 v40, v160, v161
    v_cvt_pk_bf16_f32 v41, v162, v163
    v_cvt_pk_bf16_f32 v42, v164, v165
    v_cvt_pk_bf16_f32 v43, v166, v167
    v_cvt_pk_bf16_f32 v44, v168, v169
    v_cvt_pk_bf16_f32 v45, v170, v171
    v_cvt_pk_bf16_f32 v46, v172, v173
    v_cvt_pk_bf16_f32 v47, v174, v175
    v_lshlrev_b32 v160, 16, v40
    v_and_b32 v161, 0xffff0000, v40
    v_lshlrev_b32 v162, 16, v41
    v_and_b32 v163, 0xffff0000, v41
    v_lshlrev_b32 v164, 16, v42
    v_and_b32 v165, 0xffff0000, v42
    v_lshlrev_b32 v166, 16, v43
    v_and_b32 v167, 0xffff0000, v43
    v_lshlrev_b32 v168, 16, v44
    v_and_b32 v169, 0xffff0000, v44
    v_lshlrev_b32 v170, 16, v45
    v_and_b32 v171, 0xffff0000, v45
    v_lshlrev_b32 v172, 16, v46
    v_and_b32 v173, 0xffff0000, v46
    v_lshlrev_b32 v174, 16, v47
    v_and_b32 v175, 0xffff0000, v47
    v_lshlrev_b32 v64, 16, v116
    v_and_b32 v72, 0xffff0000, v116
    v_fmac_f32 v18, v144, v64
    v_fmac_f32 v19, v144, v72
    v_mul_f32 v64, v160, v64
    v_mul_f32 v72, v160, v72
    v_lshlrev_b32 v65, 16, v117
    v_and_b32 v73, 0xffff0000, v117
    v_fmac_f32 v18, v145, v65
    v_fmac_f32 v19, v145, v73
    v_mul_f32 v65, v161, v65
    v_mul_f32 v73, v161, v73
    v_lshlrev_b32 v66, 16, v118
    v_and_b32 v74, 0xffff0000, v118
    v_fmac_f32 v18, v146, v66
    v_fmac_f32 v19, v146, v74
    v_mul_f32 v66, v162, v66
    v_mul_f32 v74, v162, v74
    v_lshlrev_b32 v67, 16, v119
    v_and_b32 v75, 0xffff0000, v119
    v_fmac_f32 v18, v147, v67
    v_fmac_f32 v19, v147, v75
    v_mul_f32 v67, v163, v67
    v_mul_f32 v75, v163, v75
    v_lshlrev_b32 v68, 16, v120
    v_and_b32 v76, 0xffff0000, v120
    v_fmac_f32 v18, v148, v68
    v_fmac_f32 v19, v148, v76
    v_mul_f32 v68, v164, v68
    v_mul_f32 v76, v164, v76
    v_lshlrev_b32 v69, 16, v121
    v_and_b32 v77, 0xffff0000, v121
    v_fmac_f32 v18, v149, v69
    v_fmac_f32 v19, v149, v77
    v_mul_f32 v69, v165, v69
    v_mul_f32 v77, v165, v77
    v_lshlrev_b32 v70, 16, v122
    v_and_b32 v78, 0xffff0000, v122
    v_fmac_f32 v18, v150, v70
    v_fmac_f32 v19, v150, v78
    v_mul_f32 v70, v166, v70
    v_mul_f32 v78, v166, v78
    v_lshlrev_b32 v71, 16, v123
    v_and_b32 v79, 0xffff0000, v123
    v_fmac_f32 v18, v151, v71
    v_fmac_f32 v19, v151, v79
    v_mul_f32 v71, v167, v71
    v_mul_f32 v79, v167, v79
    v_cvt_pk_bf16_f32 v32, v64, v65
    v_cvt_pk_bf16_f32 v36, v72, v73
    v_cvt_pk_bf16_f32 v33, v66, v67
    v_cvt_pk_bf16_f32 v37, v74, v75
    v_cvt_pk_bf16_f32 v34, v68, v69
    v_cvt_pk_bf16_f32 v38, v76, v77
    v_cvt_pk_bf16_f32 v35, v70, v71
    v_cvt_pk_bf16_f32 v39, v78, v79
    v_dot2c_f32_bf16 v16, v32, v10
    v_dot2c_f32_bf16 v17, v36, v10
    v_dot2c_f32_bf16 v16, v33, v10
    v_dot2c_f32_bf16 v17, v37, v10
    v_dot2c_f32_bf16 v16, v34, v10
    v_dot2c_f32_bf16 v17, v38, v10
    v_dot2c_f32_bf16 v16, v35, v10
    v_dot2c_f32_bf16 v17, v39, v10
    buffer_store_dwordx4 v[32:35], v6, s[12:15], s29 offen offset:0
    buffer_store_dwordx4 v[36:39], v6, s[12:15], s29 offen offset:16
    v_lshlrev_b32 v64, 16, v124
    v_and_b32 v72, 0xffff0000, v124
    v_fmac_f32 v18, v152, v64
    v_fmac_f32 v19, v152, v72
    v_mul_f32 v64, v168, v64
    v_mul_f32 v72, v168, v72
    v_lshlrev_b32 v65, 16, v125
    v_and_b32 v73, 0xffff0000, v125
    v_fmac_f32 v18, v153, v65
    v_fmac_f32 v19, v153, v73
    v_mul_f32 v65, v169, v65
    v_mul_f32 v73, v169, v73
    v_lshlrev_b32 v66, 16, v126
    v_and_b32 v74, 0xffff0000, v126
    v_fmac_f32 v18, v154, v66
    v_fmac_f32 v19, v154, v74
    v_mul_f32 v66, v170, v66
    v_mul_f32 v74, v170, v74
    v_lshlrev_b32 v67, 16, v127
    v_and_b32 v75, 0xffff0000, v127
    v_fmac_f32 v18, v155, v67
    v_fmac_f32 v19, v155, v75
    v_mul_f32 v67, v171, v67
    v_mul_f32 v75, v171, v75
    v_lshlrev_b32 v68, 16, v128
    v_and_b32 v76, 0xffff0000, v128
    v_fmac_f32 v18, v156, v68
    v_fmac_f32 v19, v156, v76
    v_mul_f32 v68, v172, v68
    v_mul_f32 v76, v172, v76
    v_lshlrev_b32 v69, 16, v129
    v_and_b32 v77, 0xffff0000, v129
    v_fmac_f32 v18, v157, v69
    v_fmac_f32 v19, v157, v77
    v_mul_f32 v69, v173, v69
    v_mul_f32 v77, v173, v77
    v_lshlrev_b32 v70, 16, v130
    v_and_b32 v78, 0xffff0000, v130
    v_fmac_f32 v18, v158, v70
    v_fmac_f32 v19, v158, v78
    v_mul_f32 v70, v174, v70
    v_mul_f32 v78, v174, v78
    v_lshlrev_b32 v71, 16, v131
    v_and_b32 v79, 0xffff0000, v131
    v_fmac_f32 v18, v159, v71
    v_fmac_f32 v19, v159, v79
    v_mul_f32 v71, v175, v71
    v_mul_f32 v79, v175, v79
    v_cvt_pk_bf16_f32 v40, v64, v65
    v_cvt_pk_bf16_f32 v44, v72, v73
    v_cvt_pk_bf16_f32 v41, v66, v67
    v_cvt_pk_bf16_f32 v45, v74, v75
    v_cvt_pk_bf16_f32 v42, v68, v69
    v_cvt_pk_bf16_f32 v46, v76, v77
    v_cvt_pk_bf16_f32 v43, v70, v71
    v_cvt_pk_bf16_f32 v47, v78, v79
    v_dot2c_f32_bf16 v16, v40, v10
    v_dot2c_f32_bf16 v17, v44, v10
    v_dot2c_f32_bf16 v16, v41, v10
    v_dot2c_f32_bf16 v17, v45, v10
    v_dot2c_f32_bf16 v16, v42, v10
    v_dot2c_f32_bf16 v17, v46, v10
    v_dot2c_f32_bf16 v16, v43, v10
    v_dot2c_f32_bf16 v17, v47, v10
    buffer_store_dwordx4 v[40:43], v6, s[12:15], s29 offen offset:512
    buffer_store_dwordx4 v[44:47], v6, s[12:15], s29 offen offset:528
    s_nop 1
    v_permlane32_swap_b32 v16, v18
    v_permlane32_swap_b32 v17, v19
    v_add_f32 v16, v16, v18
    v_add_f32 v17, v17, v19
    v_and_b32 v11, 255, v0
    v_lshlrev_b32 v11, 3, v11
    v_add_u32 v11, 125568, v11
    ds_write_b64 v11, v[16:17]
    v_mov_b32 v92, 1
    v_mov_b32 v93, 125504
    v_lshlrev_b32 v12, 3, v3
    v_add_u32 v12, 125568, v12
    s_mov_b64 exec, 1
    s_waitcnt lgkmcnt(0)
    ds_add_rtn_u32 v94, v93, v92
    s_waitcnt lgkmcnt(0)
    v_readfirstlane_b32 s22, v94
    s_mov_b64 exec, -1
    s_cmp_lg_u32 s22, 11
    s_cbranch_scc1 KAB_END
    ds_read_b64 v[16:17], v12 offset:0
    ds_read_b64 v[18:19], v12 offset:512
    ds_read_b64 v[20:21], v12 offset:1024
    ds_read_b64 v[22:23], v12 offset:1536
    v_lshrrev_b32 v7, 3, v113
    v_lshlrev_b32 v6, 7, v7
    v_lshl_add_u32 v6, v8, 6, v6
    v_bfe_u32 v7, v113, 1, 1
    v_lshl_add_u32 v6, v7, 5, v6
    v_lshl_add_u32 v6, v9, 3, v6
    v_lshrrev_b32 v7, 5, v3
    v_lshl_add_u32 v6, v7, 14, v6
    s_lshl_b32 s29, s31, 9
    s_lshl_b32 s28, s23, 4
    s_add_u32 s29, s29, s28
    s_lshl_b32 s28, s30, 15
    s_add_u32 s29, s29, s28
    s_waitcnt lgkmcnt(0)
    v_pk_add_f32 v[16:17], v[16:17], v[18:19]
    v_pk_add_f32 v[16:17], v[16:17], v[20:21]
    v_pk_add_f32 v[16:17], v[16:17], v[22:23]
    buffer_store_dwordx2 v[16:17], v6, s[24:27], s29 offen
KAB_END:
    s_endpgm
    .globl kc_kernel
    .p2align 8
    .type kc_kernel,@function
kc_kernel:
    s_cmp_ge_u32 s2, 256
    s_cbranch_scc1 KC_END
    s_load_dwordx4 s[40:43], s[0:1], 120
    s_load_dwordx2 s[16:17], s[0:1], 136
    s_and_b32 s44, s2, 3
    s_lshl_b32 s44, s44, 3
    s_bfe_u32 s45, s2, 0x30003
    s_add_u32 s44, s44, s45
    s_bfe_u32 s45, s2, 0x10002
    s_lshl_b32 s45, s45, 2
    s_lshr_b32 s46, s2, 6
    s_add_u32 s45, s45, s46
    s_and_b32 s20, s2, 3
    s_lshl_b32 s20, s20, 2
    s_bfe_u32 s21, s2, 0x20003
    s_add_u32 s20, s20, s21
    s_bfe_u32 s21, s2, 0x10002
    s_mul_i32 s21, s21, 7
    s_lshr_b32 s22, s2, 5
    s_add_u32 s21, s21, s22
    v_lshrrev_b32 v1, 6, v0
    v_and_b32 v2, 63, v0
    v_lshlrev_b32 v3, 4, v2
    v_readfirstlane_b32 s22, v1
    s_waitcnt lgkmcnt(0)
    s_add_u32 s4, s16, 10485760
    s_addc_u32 s5, s17, 0
    s_mov_b32 s6, 2097152
    s_mov_b32 s7, 0x00020000
    s_add_u32 s8, s16, 12582912
    s_addc_u32 s9, s17, 0
    s_mov_b32 s10, 3670016
    s_mov_b32 s11, 0x00020000
    s_add_u32 s12, s16, 20971520
    s_addc_u32 s13, s17, 0
    s_mov_b32 s14, 7340032
    s_mov_b32 s15, 0x00020000
    s_add_u32 s24, s16, 262144
    s_addc_u32 s25, s17, 0
    s_mov_b32 s26, 131072
    s_mov_b32 s27, 0x00020000
    s_add_u32 s48, s16, 17825792
    s_addc_u32 s49, s17, 0
    s_mov_b32 s50, 1835008
    s_mov_b32 s51, 0x00020000
    s_add_u32 s52, s16, 393216
    s_addc_u32 s53, s17, 0
    s_mov_b32 s54, 4096
    s_mov_b32 s55, 0x00020000
    s_mul_i32 s46, s45, 229376
    s_mul_i32 s47, s22, 14336
    s_add_u32 s46, s46, s47
    s_mul_i32 s56, s44, 229376
    s_add_u32 s56, s56, s47
    v_add_u32 v11, 114688, v3
    v_mov_b32 v1, 0x20800
    v_mov_b32 v14, 0
    ds_write_b32 v1, v14
    s_mov_b32 s42, 0x200000
    s_mov_b32 s43, 0x00020000
    s_cmp_ge_u32 s2, 224
    s_cbranch_scc1 KC_P2
    s_lshl_b32 s23, s21, 3
    s_add_u32 s23, s23, s22
    s_lshl_b32 s28, s23, 15
    s_and_b32 s30, s22, 3
    s_lshl_b32 s30, s30, 15
    s_lshr_b32 s31, s22, 2
    s_lshl_b32 s31, s31, 11
    s_add_u32 s30, s30, s31
    s_lshl_b32 s29, s20, 17
    s_add_u32 s29, s29, s30
    s_add_u32 s31, s29, 0
    s_add_u32 m0, s30, 0
    s_nop 0
    buffer_load_dwordx4 v3, s[4:7], s31 offen lds
    buffer_load_dwordx4 v3, s[4:7], s31 offen offset:1024 lds
    s_add_u32 s32, s28, 0
    buffer_load_dwordx4 v[64:67], v3, s[8:11], s32 offen offset:0
    s_add_u32 s31, s29, 4096
    s_add_u32 m0, s30, 4096
    s_nop 0
    buffer_load_dwordx4 v3, s[4:7], s31 offen lds
    buffer_load_dwordx4 v3, s[4:7], s31 offen offset:1024 lds
    buffer_load_dwordx4 v[68:71], v3, s[8:11], s32 offen offset:1024
    buffer_load_dwordx4 v[72:75], v3, s[8:11], s32 offen offset:2048
    buffer_load_dwordx4 v[76:79], v3, s[8:11], s32 offen offset:3072
    s_add_u32 s31, s29, 8192
    s_add_u32 m0, s30, 8192
    s_nop 0
    buffer_load_dwordx4 v3, s[4:7], s31 offen lds
    buffer_load_dwordx4 v3, s[4:7], s31 offen offset:1024 lds
    s_add_u32 s32, s28, 4096
    buffer_load_dwordx4 v[80:83], v3, s[8:11], s32 offen offset:0
    buffer_load_dwordx4 v[84:87], v3, s[8:11], s32 offen offset:1024
    v_lshrrev_b32 v4, 5, v2
    v_lshlrev_b32 v4, 6, v4
    s_lshl_b32 s33, s23, 7
    s_add_u32 s34, s33, 16384
    v_add_u32 v5, 0x10000, v3
    v_mov_b32 v6, 0x3f803f80
    v_add_u32 v7, s30, v3
    v_mov_b32 v8, 0
    v_mov_b32 v9, 0
    v_mov_b32 v58, 0
    v_mov_b32 v59, 0
    s_waitcnt vmcnt(10)
    s_barrier
    ds_read_b128 v[16:19], v3 offset:0
    ds_read_b128 v[20:23], v3 offset:32768
    ds_read_b128 v[24:27], v5 offset:0
    ds_read_b128 v[28:31], v5 offset:32768
    ds_read_b128 v[32:35], v3 offset:1024
    ds_read_b128 v[36:39], v3 offset:33792
    ds_read_b128 v[40:43], v5 offset:1024
    ds_read_b128 v[44:47], v5 offset:33792
    ds_read_b128 v[48:51], v7 offset:0
    ds_read_b128 v[52:55], v7 offset:1024
    s_waitcnt vmcnt(9) lgkmcnt(6)
    v_mfma_f32_32x32x16_bf16 v[128:143], v[64:67], v[16:19], 0
    buffer_load_dwordx4 v[88:91], v3, s[8:11], s32 offen offset:2048
    v_mfma_f32_32x32x16_bf16 v[144:159], v[64:67], v[20:23], 0
    s_add_u32 s31, s29, 12288
    s_add_u32 m0, s30, 12288
    s_nop 0
    buffer_load_dwordx4 v3, s[4:7], s31 offen lds
    buffer_load_dwordx4 v3, s[4:7], s31 offen offset:1024 lds
    v_mfma_f32_32x32x16_bf16 v[160:175], v[64:67], v[24:27], 0
    buffer_load_dwordx4 v[92:95], v3, s[8:11], s32 offen offset:3072
    v_mfma_f32_32x32x16_bf16 v[176:191], v[64:67], v[28:31], 0
    s_add_u32 s32, s28, 8192
    buffer_load_dwordx4 v[96:99], v3, s[8:11], s32 offen offset:0
    ds_read_b128 v[16:19], v3 offset:2048
    ds_read_b128 v[20:23], v3 offset:34816
    ds_read_b128 v[24:27], v5 offset:2048
    ds_read_b128 v[28:31], v5 offset:34816
    s_waitcnt vmcnt(11) lgkmcnt(4)
    v_mfma_f32_32x32x16_bf16 v[128:143], v[68:71], v[32:35], v[128:143]
    buffer_load_dwordx4 v[100:103], v3, s[8:11], s32 offen offset:1024
    v_lshlrev_b32 v56, 16, v48
    v_and_b32 v57, 0xffff0000, v48
    v_add_f32 v8, v8, v56
    v_fmac_f32 v9, v56, v56
    v_add_f32 v58, v58, v57
    v_fmac_f32 v59, v57, v57
    v_mfma_f32_32x32x16_bf16 v[144:159], v[68:71], v[36:39], v[144:159]
    v_lshlrev_b32 v56, 16, v49
    v_and_b32 v57, 0xffff0000, v49
    v_add_f32 v8, v8, v56
    v_fmac_f32 v9, v56, v56
    v_add_f32 v58, v58, v57
    v_fmac_f32 v59, v57, v57
    v_and_b32 v12, 31, v2
    v_lshlrev_b32 v12, 2, v12
    v_lshl_add_u32 v12, v4, 8, v12
    s_lshl_b32 s58, s22, 8
    s_add_u32 s58, s58, 0x20840
    v_lshl_add_u32 v13, v2, 2, s58
    v_add_u32 v4, s58, v4
    buffer_load_dword v248, v12, s[24:27], s33 offen
    s_add_u32 s33, s33, 32768
    buffer_load_dword v249, v12, s[24:27], s33 offen
    s_add_u32 s33, s33, 32768
    buffer_load_dword v250, v12, s[24:27], s33 offen
    s_add_u32 s33, s33, 32768
    buffer_load_dword v251, v12, s[24:27], s33 offen
    s_add_u32 s33, s33, 32768
    v_mfma_f32_32x32x16_bf16 v[160:175], v[68:71], v[40:43], v[160:175]
    v_lshlrev_b32 v56, 16, v50
    v_and_b32 v57, 0xffff0000, v50
    v_add_f32 v8, v8, v56
    v_fmac_f32 v9, v56, v56
    v_add_f32 v58, v58, v57
    v_fmac_f32 v59, v57, v57
    v_mfma_f32_32x32x16_bf16 v[176:191], v[68:71], v[44:47], v[176:191]
    v_lshlrev_b32 v56, 16, v51
    v_and_b32 v57, 0xffff0000, v51
    v_add_f32 v8, v8, v56
    v_fmac_f32 v9, v56, v56
    v_add_f32 v58, v58, v57
    v_fmac_f32 v59, v57, v57
    ds_read_b128 v[32:35], v3 offset:3072
    ds_read_b128 v[36:39], v3 offset:35840
    ds_read_b128 v[40:43], v5 offset:3072
    ds_read_b128 v[44:47], v5 offset:35840
    s_waitcnt vmcnt(15) lgkmcnt(4)
    v_mfma_f32_32x32x16_bf16 v[128:143], v[72:75], v[16:19], v[128:143]
    s_add_u32 s31, s29, 16384
    s_add_u32 m0, s30, 16384
    s_nop 0
    buffer_load_dwordx4 v3, s[4:7], s31 offen lds
    buffer_load_dwordx4 v3, s[4:7], s31 offen offset:1024 lds
    v_lshlrev_b32 v56, 16, v52
    v_and_b32 v57, 0xffff0000, v52
    v_add_f32 v8, v8, v56
    v_fmac_f32 v9, v56, v56
    v_add_f32 v58, v58, v57
    v_fmac_f32 v59, v57, v57
    v_mfma_f32_32x32x16_bf16 v[144:159], v[72:75], v[20:23], v[144:159]
    buffer_load_dwordx4 v[104:107], v3, s[8:11], s32 offen offset:2048
    v_lshlrev_b32 v56, 16, v53
    v_and_b32 v57, 0xffff0000, v53
    v_add_f32 v8, v8, v56
    v_fmac_f32 v9, v56, v56
    v_add_f32 v58, v58, v57
    v_fmac_f32 v59, v57, v57
    v_mfma_f32_32x32x16_bf16 v[160:175], v[72:75], v[24:27], v[160:175]
    v_lshlrev_b32 v56, 16, v54
    v_and_b32 v57, 0xffff0000, v54
    v_add_f32 v8, v8, v56
    v_fmac_f32 v9, v56, v56
    v_add_f32 v58, v58, v57
    v_fmac_f32 v59, v57, v57
    v_mfma_f32_32x32x16_bf16 v[176:191], v[72:75], v[28:31], v[176:191]
    v_lshlrev_b32 v56, 16, v55
    v_and_b32 v57, 0xffff0000, v55
    v_add_f32 v8, v8, v56
    v_fmac_f32 v9, v56, v56
    v_add_f32 v58, v58, v57
    v_fmac_f32 v59, v57, v57
    s_barrier
    ds_read_b128 v[16:19], v3 offset:4096
    ds_read_b128 v[20:23], v3 offset:36864
    ds_read_b128 v[24:27], v5 offset:4096
    ds_read_b128 v[28:31], v5 offset:36864
    ds_read_b128 v[48:51], v7 offset:4096
    ds_read_b128 v[52:55], v7 offset:5120
    s_waitcnt vmcnt(17) lgkmcnt(6)
    v_mfma_f32_32x32x16_bf16 v[128:143], v[76:79], v[32:35], v[128:143]
    buffer_load_dwordx4 v[108:111], v3, s[8:11], s32 offen offset:3072
    v_mfma_f32_32x32x16_bf16 v[144:159], v[76:79], v[36:39], v[144:159]
    v_mfma_f32_32x32x16_bf16 v[160:175], v[76:79], v[40:43], v[160:175]
    v_mfma_f32_32x32x16_bf16 v[176:191], v[76:79], v[44:47], v[176:191]
    ds_read_b128 v[32:35], v3 offset:5120
    ds_read_b128 v[36:39], v3 offset:37888
    ds_read_b128 v[40:43], v5 offset:5120
    ds_read_b128 v[44:47], v5 offset:37888
    s_waitcnt vmcnt(15) lgkmcnt(4)
    v_mfma_f32_32x32x16_bf16 v[128:143], v[80:83], v[16:19], v[128:143]
    s_add_u32 s32, s28, 12288
    buffer_load_dwordx4 v[112:115], v3, s[8:11], s32 offen offset:0
    v_lshlrev_b32 v56, 16, v48
    v_and_b32 v57, 0xffff0000, v48
    v_add_f32 v8, v8, v56
    v_fmac_f32 v9, v56, v56
    v_add_f32 v58, v58, v57
    v_fmac_f32 v59, v57, v57
    v_mfma_f32_32x32x16_bf16 v[144:159], v[80:83], v[20:23], v[144:159]
    v_lshlrev_b32 v56, 16, v49
    v_and_b32 v57, 0xffff0000, v49
    v_add_f32 v8, v8, v56
    v_fmac_f32 v9, v56, v56
    v_add_f32 v58, v58, v57
    v_fmac_f32 v59, v57, v57
    v_mfma_f32_32x32x16_bf16 v[160:175], v[80:83], v[24:27], v[160:175]
    v_lshlrev_b32 v56, 16, v50
    v_and_b32 v57, 0xffff0000, v50
    v_add_f32 v8, v8, v56
    v_fmac_f32 v9, v56, v56
    v_add_f32 v58, v58, v57
    v_fmac_f32 v59, v57, v57
    v_mfma_f32_32x32x16_bf16 v[176:191], v[80:83], v[28:31], v[176:191]
    v_lshlrev_b32 v56, 16, v51
    v_and_b32 v57, 0xffff0000, v51
    v_add_f32 v8, v8, v56
    v_fmac_f32 v9, v56, v56
    v_add_f32 v58, v58, v57
    v_fmac_f32 v59, v57, v57
    ds_read_b128 v[16:19], v3 offset:6144
    ds_read_b128 v[20:23], v3 offset:38912
    ds_read_b128 v[24:27], v5 offset:6144
    ds_read_b128 v[28:31], v5 offset:38912
    s_waitcnt vmcnt(15) lgkmcnt(4)
    v_mfma_f32_32x32x16_bf16 v[128:143], v[84:87], v[32:35], v[128:143]
    s_add_u32 s31, s29, 20480
    s_add_u32 m0, s30, 20480
    s_nop 0
    buffer_load_dwordx4 v3, s[4:7], s31 offen lds
    buffer_load_dwordx4 v3, s[4:7], s31 offen offset:1024 lds
    v_lshlrev_b32 v56, 16, v52
    v_and_b32 v57, 0xffff0000, v52
    v_add_f32 v8, v8, v56
    v_fmac_f32 v9, v56, v56
    v_add_f32 v58, v58, v57
    v_fmac_f32 v59, v57, v57
    v_mfma_f32_32x32x16_bf16 v[144:159], v[84:87], v[36:39], v[144:159]
    buffer_load_dwordx4 v[116:119], v3, s[8:11], s32 offen offset:1024
    v_lshlrev_b32 v56, 16, v53
    v_and_b32 v57, 0xffff0000, v53
    v_add_f32 v8, v8, v56
    v_fmac_f32 v9, v56, v56
    v_add_f32 v58, v58, v57
    v_fmac_f32 v59, v57, v57
    v_mfma_f32_32x32x16_bf16 v[160:175], v[84:87], v[40:43], v[160:175]
    v_lshlrev_b32 v56, 16, v54
    v_and_b32 v57, 0xffff0000, v54
    v_add_f32 v8, v8, v56
    v_fmac_f32 v9, v56, v56
    v_add_f32 v58, v58, v57
    v_fmac_f32 v59, v57, v57
    v_mfma_f32_32x32x16_bf16 v[176:191], v[84:87], v[44:47], v[176:191]
    v_lshlrev_b32 v56, 16, v55
    v_and_b32 v57, 0xffff0000, v55
    v_add_f32 v8, v8, v56
    v_fmac_f32 v9, v56, v56
    v_add_f32 v58, v58, v57
    v_fmac_f32 v59, v57, v57
    ds_read_b128 v[32:35], v3 offset:7168
    ds_read_b128 v[36:39], v3 offset:39936
    ds_read_b128 v[40:43], v5 offset:7168
    ds_read_b128 v[44:47], v5 offset:39936
    ds_read_b128 v[48:51], v7 offset:8192
    ds_read_b128 v[52:55], v7 offset:9216
    s_waitcnt vmcnt(17) lgkmcnt(6)
    v_mfma_f32_32x32x16_bf16 v[128:143], v[88:91], v[16:19], v[128:143]
    buffer_load_dwordx4 v[120:123], v3, s[8:11], s32 offen offset:2048
    v_mfma_f32_32x32x16_bf16 v[144:159], v[88:91], v[20:23], v[144:159]
    v_mfma_f32_32x32x16_bf16 v[160:175], v[88:91], v[24:27], v[160:175]
    v_mfma_f32_32x32x16_bf16 v[176:191], v[88:91], v[28:31], v[176:191]
    s_barrier
    ds_read_b128 v[16:19], v3 offset:8192
    ds_read_b128 v[20:23], v3 offset:40960
    ds_read_b128 v[24:27], v5 offset:8192
    ds_read_b128 v[28:31], v5 offset:40960
    s_waitcnt vmcnt(15) lgkmcnt(4)
    v_mfma_f32_32x32x16_bf16 v[128:143], v[92:95], v[32:35], v[128:143]
    buffer_load_dwordx4 v[124:127], v3, s[8:11], s32 offen offset:3072
    v_lshlrev_b32 v56, 16, v48
    v_and_b32 v57, 0xffff0000, v48
    v_add_f32 v8, v8, v56
    v_fmac_f32 v9, v56, v56
    v_add_f32 v58, v58, v57
    v_fmac_f32 v59, v57, v57
    v_mfma_f32_32x32x16_bf16 v[144:159], v[92:95], v[36:39], v[144:159]
    v_lshlrev_b32 v56, 16, v49
    v_and_b32 v57, 0xffff0000, v49
    v_add_f32 v8, v8, v56
    v_fmac_f32 v9, v56, v56
    v_add_f32 v58, v58, v57
    v_fmac_f32 v59, v57, v57
    v_mfma_f32_32x32x16_bf16 v[160:175], v[92:95], v[40:43], v[160:175]
    v_lshlrev_b32 v56, 16, v50
    v_and_b32 v57, 0xffff0000, v50
    v_add_f32 v8, v8, v56
    v_fmac_f32 v9, v56, v56
    v_add_f32 v58, v58, v57
    v_fmac_f32 v59, v57, v57
    v_mfma_f32_32x32x16_bf16 v[176:191], v[92:95], v[44:47], v[176:191]
    v_lshlrev_b32 v56, 16, v51
    v_and_b32 v57, 0xffff0000, v51
    v_add_f32 v8, v8, v56
    v_fmac_f32 v9, v56, v56
    v_add_f32 v58, v58, v57
    v_fmac_f32 v59, v57, v57
    ds_read_b128 v[32:35], v3 offset:9216
    ds_read_b128 v[36:39], v3 offset:41984
    ds_read_b128 v[40:43], v5 offset:9216
    ds_read_b128 v[44:47], v5 offset:41984
    s_waitcnt vmcnt(15) lgkmcnt(4)
    v_mfma_f32_32x32x16_bf16 v[128:143], v[96:99], v[16:19], v[128:143]
    s_add_u32 s31, s29, 24576
    s_add_u32 m0, s30, 24576
    s_nop 0
    buffer_load_dwordx4 v3, s[4:7], s31 offen lds
    buffer_load_dwordx4 v3, s[4:7], s31 offen offset:1024 lds
    v_lshlrev_b32 v56, 16, v52
    v_and_b32 v57, 0xffff0000, v52
    v_add_f32 v8, v8, v56
    v_fmac_f32 v9, v56, v56
    v_add_f32 v58, v58, v57
    v_fmac_f32 v59, v57, v57
    v_mfma_f32_32x32x16_bf16 v[144:159], v[96:99], v[20:23], v[144:159]
    s_add_u32 s32, s28, 16384
    buffer_load_dwordx4 v[64:67], v3, s[8:11], s32 offen offset:0
    v_lshlrev_b32 v56, 16, v53
    v_and_b32 v57, 0xffff0000, v53
    v_add_f32 v8, v8, v56
    v_fmac_f32 v9, v56, v56
    v_add_f32 v58, v58, v57
    v_fmac_f32 v59, v57, v57
    v_mfma_f32_32x32x16_bf16 v[160:175], v[96:99], v[24:27], v[160:175]
    v_lshlrev_b32 v56, 16, v54
    v_and_b32 v57, 0xffff0000, v54
    v_add_f32 v8, v8, v56
    v_fmac_f32 v9, v56, v56
    v_add_f32 v58, v58, v57
    v_fmac_f32 v59, v57, v57
    v_mfma_f32_32x32x16_bf16 v[176:191], v[96:99], v[28:31], v[176:191]
    v_lshlrev_b32 v56, 16, v55
    v_and_b32 v57, 0xffff0000, v55
    v_add_f32 v8, v8, v56
    v_fmac_f32 v9, v56, v56
    v_add_f32 v58, v58, v57
    v_fmac_f32 v59, v57, v57
    ds_read_b128 v[16:19], v3 offset:10240
    ds_read_b128 v[20:23], v3 offset:43008
    ds_read_b128 v[24:27], v5 offset:10240
    ds_read_b128 v[28:31], v5 offset:43008
    ds_read_b128 v[48:51], v7 offset:12288
    ds_read_b128 v[52:55], v7 offset:13312
    s_waitcnt vmcnt(17) lgkmcnt(6)
    v_mfma_f32_32x32x16_bf16 v[128:143], v[100:103], v[32:35], v[128:143]
    buffer_load_dwordx4 v[68:71], v3, s[8:11], s32 offen offset:1024
    v_mfma_f32_32x32x16_bf16 v[144:159], v[100:103], v[36:39], v[144:159]
    v_mfma_f32_32x32x16_bf16 v[160:175], v[100:103], v[40:43], v[160:175]
    v_mfma_f32_32x32x16_bf16 v[176:191], v[100:103], v[44:47], v[176:191]
    ds_read_b128 v[32:35], v3 offset:11264
    ds_read_b128 v[36:39], v3 offset:44032
    ds_read_b128 v[40:43], v5 offset:11264
    ds_read_b128 v[44:47], v5 offset:44032
    s_waitcnt vmcnt(11) lgkmcnt(4)
    v_mfma_f32_32x32x16_bf16 v[128:143], v[104:107], v[16:19], v[128:143]
    buffer_load_dwordx4 v[72:75], v3, s[8:11], s32 offen offset:2048
    v_lshlrev_b32 v56, 16, v48
    v_and_b32 v57, 0xffff0000, v48
    v_add_f32 v8, v8, v56
    v_fmac_f32 v9, v56, v56
    v_add_f32 v58, v58, v57
    v_fmac_f32 v59, v57, v57
    v_mfma_f32_32x32x16_bf16 v[144:159], v[104:107], v[20:23], v[144:159]
    v_lshlrev_b32 v56, 16, v49
    v_and_b32 v57, 0xffff0000, v49
    v_add_f32 v8, v8, v56
    v_fmac_f32 v9, v56, v56
    v_add_f32 v58, v58, v57
    v_fmac_f32 v59, v57, v57
    v_mfma_f32_32x32x16_bf16 v[160:175], v[104:107], v[24:27], v[160:175]
    v_lshlrev_b32 v56, 16, v50
    v_and_b32 v57, 0xffff0000, v50
    v_add_f32 v8, v8, v56
    v_fmac_f32 v9, v56, v56
    v_add_f32 v58, v58, v57
    v_fmac_f32 v59, v57, v57
    v_mfma_f32_32x32x16_bf16 v[176:191], v[104:107], v[28:31], v[176:191]
    v_lshlrev_b32 v56, 16, v51
    v_and_b32 v57, 0xffff0000, v51
    v_add_f32 v8, v8, v56
    v_fmac_f32 v9, v56, v56
    v_add_f32 v58, v58, v57
    v_fmac_f32 v59, v57, v57
    s_barrier
    ds_read_b128 v[16:19], v3 offset:12288
    ds_read_b128 v[20:23], v3 offset:45056
    ds_read_b128 v[24:27], v5 offset:12288
    ds_read_b128 v[28:31], v5 offset:45056
    s_waitcnt vmcnt(11) lgkmcnt(4)
    v_mfma_f32_32x32x16_bf16 v[128:143], v[108:111], v[32:35], v[128:143]
    s_add_u32 s31, s29, 28672
    s_add_u32 m0, s30, 28672
    s_nop 0
    buffer_load_dwordx4 v3, s[4:7], s31 offen lds
    buffer_load_dwordx4 v3, s[4:7], s31 offen offset:1024 lds
    v_lshlrev_b32 v56, 16, v52
    v_and_b32 v57, 0xffff0000, v52
    v_add_f32 v8, v8, v56
    v_fmac_f32 v9, v56, v56
    v_add_f32 v58, v58, v57
    v_fmac_f32 v59, v57, v57
    v_mfma_f32_32x32x16_bf16 v[144:159], v[108:111], v[36:39], v[144:159]
    buffer_load_dwordx4 v[76:79], v3, s[8:11], s32 offen offset:3072
    v_lshlrev_b32 v56, 16, v53
    v_and_b32 v57, 0xffff0000, v53
    v_add_f32 v8, v8, v56
    v_fmac_f32 v9, v56, v56
    v_add_f32 v58, v58, v57
    v_fmac_f32 v59, v57, v57
    v_mfma_f32_32x32x16_bf16 v[160:175], v[108:111], v[40:43], v[160:175]
    v_lshlrev_b32 v56, 16, v54
    v_and_b32 v57, 0xffff0000, v54
    v_add_f32 v8, v8, v56
    v_fmac_f32 v9, v56, v56
    v_add_f32 v58, v58, v57
    v_fmac_f32 v59, v57, v57
    v_mfma_f32_32x32x16_bf16 v[176:191], v[108:111], v[44:47], v[176:191]
    v_lshlrev_b32 v56, 16, v55
    v_and_b32 v57, 0xffff0000, v55
    v_add_f32 v8, v8, v56
    v_fmac_f32 v9, v56, v56
    v_add_f32 v58, v58, v57
    v_fmac_f32 v59, v57, v57
    ds_read_b128 v[32:35], v3 offset:13312
    ds_read_b128 v[36:39], v3 offset:46080
    ds_read_b128 v[40:43], v5 offset:13312
    ds_read_b128 v[44:47], v5 offset:46080
    ds_read_b128 v[48:51], v7 offset:16384
    ds_read_b128 v[52:55], v7 offset:17408
    s_waitcnt vmcnt(13) lgkmcnt(6)
    v_mfma_f32_32x32x16_bf16 v[128:143], v[112:115], v[16:19], v[128:143]
    s_add_u32 s32, s28, 20480
    buffer_load_dwordx4 v[80:83], v3, s[8:11], s32 offen offset:0
    v_mfma_f32_32x32x16_bf16 v[144:159], v[112:115], v[20:23], v[144:159]
    v_mfma_f32_32x32x16_bf16 v[160:175], v[112:115], v[24:27], v[160:175]
    v_mfma_f32_32x32x16_bf16 v[176:191], v[112:115], v[28:31], v[176:191]
    v_add_f32 v248, v248, v249
    v_add_f32 v248, v248, v250
    v_add_f32 v248, v248, v251
    ds_write_b32 v13, v248
    ds_read_b128 v[16:19], v3 offset:14336
    ds_read_b128 v[20:23], v3 offset:47104
    ds_read_b128 v[24:27], v5 offset:14336
    ds_read_b128 v[28:31], v5 offset:47104
    s_waitcnt vmcnt(11) lgkmcnt(4)
    v_mfma_f32_32x32x16_bf16 v[128:143], v[116:119], v[32:35], v[128:143]
    buffer_load_dwordx4 v[84:87], v3, s[8:11], s32 offen offset:1024
    v_lshlrev_b32 v56, 16, v48
    v_and_b32 v57, 0xffff0000, v48
    v_add_f32 v8, v8, v56
    v_fmac_f32 v9, v56, v56
    v_add_f32 v58, v58, v57
    v_fmac_f32 v59, v57, v57
    v_mfma_f32_32x32x16_bf16 v[144:159], v[116:119], v[36:39], v[144:159]
    v_lshlrev_b32 v56, 16, v49
    v_and_b32 v57, 0xffff0000, v49
    v_add_f32 v8, v8, v56
    v_fmac_f32 v9, v56, v56
    v_add_f32 v58, v58, v57
    v_fmac_f32 v59, v57, v57
    v_mfma_f32_32x32x16_bf16 v[160:175], v[116:119], v[40:43], v[160:175]
    v_lshlrev_b32 v56, 16, v50
    v_and_b32 v57, 0xffff0000, v50
    v_add_f32 v8, v8, v56
    v_fmac_f32 v9, v56, v56
    v_add_f32 v58, v58, v57
    v_fmac_f32 v59, v57, v57
    v_mfma_f32_32x32x16_bf16 v[176:191], v[116:119], v[44:47], v[176:191]
    v_lshlrev_b32 v56, 16, v51
    v_and_b32 v57, 0xffff0000, v51
    v_add_f32 v8, v8, v56
    v_fmac_f32 v9, v56, v56
    v_add_f32 v58, v58, v57
    v_fmac_f32 v59, v57, v57
    ds_read_b128 v[32:35], v3 offset:15360
    ds_read_b128 v[36:39], v3 offset:48128
    ds_read_b128 v[40:43], v5 offset:15360
    ds_read_b128 v[44:47], v5 offset:48128
    s_waitcnt vmcnt(11) lgkmcnt(4)
    v_mfma_f32_32x32x16_bf16 v[128:143], v[120:123], v[16:19], v[128:143]
    buffer_load_dwordx4 v[88:91], v3, s[8:11], s32 offen offset:2048
    v_lshlrev_b32 v56, 16, v52
    v_and_b32 v57, 0xffff0000, v52
    v_add_f32 v8, v8, v56
    v_fmac_f32 v9, v56, v56
    v_add_f32 v58, v58, v57
    v_fmac_f32 v59, v57, v57
    v_mfma_f32_32x32x16_bf16 v[144:159], v[120:123], v[20:23], v[144:159]
    v_lshlrev_b32 v56, 16, v53
    v_and_b32 v57, 0xffff0000, v53
    v_add_f32 v8, v8, v56
    v_fmac_f32 v9, v56, v56
    v_add_f32 v58, v58, v57
    v_fmac_f32 v59, v57, v57
    v_mfma_f32_32x32x16_bf16 v[160:175], v[120:123], v[24:27], v[160:175]
    v_lshlrev_b32 v56, 16, v54
    v_and_b32 v57, 0xffff0000, v54
    v_add_f32 v8, v8, v56
    v_fmac_f32 v9, v56, v56
    v_add_f32 v58, v58, v57
    v_fmac_f32 v59, v57, v57
    v_mfma_f32_32x32x16_bf16 v[176:191], v[120:123], v[28:31], v[176:191]
    v_lshlrev_b32 v56, 16, v55
    v_and_b32 v57, 0xffff0000, v55
    v_add_f32 v8, v8, v56
    v_fmac_f32 v9, v56, v56
    v_add_f32 v58, v58, v57
    v_fmac_f32 v59, v57, v57
    s_barrier
    ds_read_b128 v[16:19], v3 offset:16384
    ds_read_b128 v[20:23], v3 offset:49152
    ds_read_b128 v[24:27], v5 offset:16384
    ds_read_b128 v[28:31], v5 offset:49152
    ds_read_b128 v[48:51], v7 offset:20480
    ds_read_b128 v[52:55], v7 offset:21504
    s_waitcnt vmcnt(11) lgkmcnt(6)
    v_mfma_f32_32x32x16_bf16 v[128:143], v[124:127], v[32:35], v[128:143]
    buffer_load_dwordx4 v[92:95], v3, s[8:11], s32 offen offset:3072
    v_mfma_f32_32x32x16_bf16 v[144:159], v[124:127], v[36:39], v[144:159]
    v_mfma_f32_32x32x16_bf16 v[160:175], v[124:127], v[40:43], v[160:175]
    v_mfma_f32_32x32x16_bf16 v[176:191], v[124:127], v[44:47], v[176:191]
    ds_read_b128 v[32:35], v3 offset:17408
    ds_read_b128 v[36:39], v3 offset:50176
    ds_read_b128 v[40:43], v5 offset:17408
    ds_read_b128 v[44:47], v5 offset:50176
    s_waitcnt vmcnt(9) lgkmcnt(4)
    v_mfma_f32_32x32x16_bf16 v[128:143], v[64:67], v[16:19], v[128:143]
    s_add_u32 s32, s28, 24576
    buffer_load_dwordx4 v[96:99], v3, s[8:11], s32 offen offset:0
    v_lshlrev_b32 v56, 16, v48
    v_and_b32 v57, 0xffff0000, v48
    v_add_f32 v8, v8, v56
    v_fmac_f32 v9, v56, v56
    v_add_f32 v58, v58, v57
    v_fmac_f32 v59, v57, v57
    v_mfma_f32_32x32x16_bf16 v[144:159], v[64:67], v[20:23], v[144:159]
    v_lshlrev_b32 v56, 16, v49
    v_and_b32 v57, 0xffff0000, v49
    v_add_f32 v8, v8, v56
    v_fmac_f32 v9, v56, v56
    v_add_f32 v58, v58, v57
    v_fmac_f32 v59, v57, v57
    v_mfma_f32_32x32x16_bf16 v[160:175], v[64:67], v[24:27], v[160:175]
    v_lshlrev_b32 v56, 16, v50
    v_and_b32 v57, 0xffff0000, v50
    v_add_f32 v8, v8, v56
    v_fmac_f32 v9, v56, v56
    v_add_f32 v58, v58, v57
    v_fmac_f32 v59, v57, v57
    v_mfma_f32_32x32x16_bf16 v[176:191], v[64:67], v[28:31], v[176:191]
    v_lshlrev_b32 v56, 16, v51
    v_and_b32 v57, 0xffff0000, v51
    v_add_f32 v8, v8, v56
    v_fmac_f32 v9, v56, v56
    v_add_f32 v58, v58, v57
    v_fmac_f32 v59, v57, v57
    ds_read_b128 v[16:19], v3 offset:18432
    ds_read_b128 v[20:23], v3 offset:51200
    ds_read_b128 v[24:27], v5 offset:18432
    ds_read_b128 v[28:31], v5 offset:51200
    s_waitcnt vmcnt(9) lgkmcnt(4)
    v_mfma_f32_32x32x16_bf16 v[128:143], v[68:71], v[32:35], v[128:143]
    buffer_load_dwordx4 v[100:103], v3, s[8:11], s32 offen offset:1024
    v_lshlrev_b32 v56, 16, v52
    v_and_b32 v57, 0xffff0000, v52
    v_add_f32 v8, v8, v56
    v_fmac_f32 v9, v56, v56
    v_add_f32 v58, v58, v57
    v_fmac_f32 v59, v57, v57
    v_mfma_f32_32x32x16_bf16 v[144:159], v[68:71], v[36:39], v[144:159]
    s_add_u32 s57, s46, 0
    buffer_load_dwordx4 v[64:67], v3, s[48:51], s57 offen offset:0
    v_lshlrev_b32 v56, 16, v53
    v_and_b32 v57, 0xffff0000, v53
    v_add_f32 v8, v8, v56
    v_fmac_f32 v9, v56, v56
    v_add_f32 v58, v58, v57
    v_fmac_f32 v59, v57, v57
    v_mfma_f32_32x32x16_bf16 v[160:175], v[68:71], v[40:43], v[160:175]
    v_lshlrev_b32 v56, 16, v54
    v_and_b32 v57, 0xffff0000, v54
    v_add_f32 v8, v8, v56
    v_fmac_f32 v9, v56, v56
    v_add_f32 v58, v58, v57
    v_fmac_f32 v59, v57, v57
    v_mfma_f32_32x32x16_bf16 v[176:191], v[68:71], v[44:47], v[176:191]
    v_lshlrev_b32 v56, 16, v55
    v_and_b32 v57, 0xffff0000, v55
    v_add_f32 v8, v8, v56
    v_fmac_f32 v9, v56, v56
    v_add_f32 v58, v58, v57
    v_fmac_f32 v59, v57, v57
    ds_read_b128 v[32:35], v3 offset:19456
    ds_read_b128 v[36:39], v3 offset:52224
    ds_read_b128 v[40:43], v5 offset:19456
    ds_read_b128 v[44:47], v5 offset:52224
    ds_read_b128 v[48:51], v7 offset:24576
    ds_read_b128 v[52:55], v7 offset:25600
    s_waitcnt vmcnt(10) lgkmcnt(6)
    v_mfma_f32_32x32x16_bf16 v[128:143], v[72:75], v[16:19], v[128:143]
    buffer_load_dwordx4 v[104:107], v3, s[8:11], s32 offen offset:2048
    v_mfma_f32_32x32x16_bf16 v[144:159], v[72:75], v[20:23], v[144:159]
    s_add_u32 s57, s46, 0
    buffer_load_dwordx4 v[68:71], v11, s[48:51], s57 offen offset:0
    v_mfma_f32_32x32x16_bf16 v[160:175], v[72:75], v[24:27], v[160:175]
    v_mfma_f32_32x32x16_bf16 v[176:191], v[72:75], v[28:31], v[176:191]
    s_barrier
    ds_read_b128 v[16:19], v3 offset:20480
    ds_read_b128 v[20:23], v3 offset:53248
    ds_read_b128 v[24:27], v5 offset:20480
    ds_read_b128 v[28:31], v5 offset:53248
    s_waitcnt vmcnt(9) lgkmcnt(4)
    v_mfma_f32_32x32x16_bf16 v[128:143], v[76:79], v[32:35], v[128:143]
    buffer_load_dwordx4 v[108:111], v3, s[8:11], s32 offen offset:3072
    v_lshlrev_b32 v56, 16, v48
    v_and_b32 v57, 0xffff0000, v48
    v_add_f32 v8, v8, v56
    v_fmac_f32 v9, v56, v56
    v_add_f32 v58, v58, v57
    v_fmac_f32 v59, v57, v57
    v_mfma_f32_32x32x16_bf16 v[144:159], v[76:79], v[36:39], v[144:159]
    s_add_u32 s57, s46, 0
    buffer_load_dwordx4 v[72:75], v3, s[48:51], s57 offen offset:1024
    v_lshlrev_b32 v56, 16, v49
    v_and_b32 v57, 0xffff0000, v49
    v_add_f32 v8, v8, v56
    v_fmac_f32 v9, v56, v56
    v_add_f32 v58, v58, v57
    v_fmac_f32 v59, v57, v57
    v_mfma_f32_32x32x16_bf16 v[160:175], v[76:79], v[40:43], v[160:175]
    v_lshlrev_b32 v56, 16, v50
    v_and_b32 v57, 0xffff0000, v50
    v_add_f32 v8, v8, v56
    v_fmac_f32 v9, v56, v56
    v_add_f32 v58, v58, v57
    v_fmac_f32 v59, v57, v57
    v_mfma_f32_32x32x16_bf16 v[176:191], v[76:79], v[44:47], v[176:191]
    v_lshlrev_b32 v56, 16, v51
    v_and_b32 v57, 0xffff0000, v51
    v_add_f32 v8, v8, v56
    v_fmac_f32 v9, v56, v56
    v_add_f32 v58, v58, v57
    v_fmac_f32 v59, v57, v57
    ds_read_b128 v[32:35], v3 offset:21504
    ds_read_b128 v[36:39], v3 offset:54272
    ds_read_b128 v[40:43], v5 offset:21504
    ds_read_b128 v[44:47], v5 offset:54272
    ds_read_b128 v[240:243], v7 offset:28672
    ds_read_b128 v[244:247], v7 offset:29696
    s_waitcnt vmcnt(10) lgkmcnt(6)
    v_mfma_f32_32x32x16_bf16 v[128:143], v[80:83], v[16:19], v[128:143]
    s_add_u32 s32, s28, 28672
    buffer_load_dwordx4 v[112:115], v3, s[8:11], s32 offen offset:0
    v_lshlrev_b32 v56, 16, v52
    v_and_b32 v57, 0xffff0000, v52
    v_add_f32 v8, v8, v56
    v_fmac_f32 v9, v56, v56
    v_add_f32 v58, v58, v57
    v_fmac_f32 v59, v57, v57
    v_mfma_f32_32x32x16_bf16 v[144:159], v[80:83], v[20:23], v[144:159]
    s_add_u32 s57, s46, 0
    buffer_load_dwordx4 v[76:79], v11, s[48:51], s57 offen offset:1024
    v_lshlrev_b32 v56, 16, v53
    v_and_b32 v57, 0xffff0000, v53
    v_add_f32 v8, v8, v56
    v_fmac_f32 v9, v56, v56
    v_add_f32 v58, v58, v57
    v_fmac_f32 v59, v57, v57
    v_mfma_f32_32x32x16_bf16 v[160:175], v[80:83], v[24:27], v[160:175]
    v_lshlrev_b32 v56, 16, v54
    v_and_b32 v57, 0xffff0000, v54
    v_add_f32 v8, v8, v56
    v_fmac_f32 v9, v56, v56
    v_add_f32 v58, v58, v57
    v_fmac_f32 v59, v57, v57
    v_mfma_f32_32x32x16_bf16 v[176:191], v[80:83], v[28:31], v[176:191]
    v_lshlrev_b32 v56, 16, v55
    v_and_b32 v57, 0xffff0000, v55
    v_add_f32 v8, v8, v56
    v_fmac_f32 v9, v56, v56
    v_add_f32 v58, v58, v57
    v_fmac_f32 v59, v57, v57
    ds_read_b128 v[16:19], v3 offset:22528
    ds_read_b128 v[20:23], v3 offset:55296
    ds_read_b128 v[24:27], v5 offset:22528
    ds_read_b128 v[28:31], v5 offset:55296
    s_waitcnt vmcnt(11) lgkmcnt(4)
    v_mfma_f32_32x32x16_bf16 v[128:143], v[84:87], v[32:35], v[128:143]
    buffer_load_dwordx4 v[116:119], v3, s[8:11], s32 offen offset:1024
    v_lshlrev_b32 v56, 16, v240
    v_and_b32 v57, 0xffff0000, v240
    v_add_f32 v8, v8, v56
    v_fmac_f32 v9, v56, v56
    v_add_f32 v58, v58, v57
    v_fmac_f32 v59, v57, v57
    v_mfma_f32_32x32x16_bf16 v[144:159], v[84:87], v[36:39], v[144:159]
    s_add_u32 s57, s46, 0
    buffer_load_dwordx4 v[80:83], v3, s[48:51], s57 offen offset:2048
    v_lshlrev_b32 v56, 16, v241
    v_and_b32 v57, 0xffff0000, v241
    v_add_f32 v8, v8, v56
    v_fmac_f32 v9, v56, v56
    v_add_f32 v58, v58, v57
    v_fmac_f32 v59, v57, v57
    v_mfma_f32_32x32x16_bf16 v[160:175], v[84:87], v[40:43], v[160:175]
    v_lshlrev_b32 v56, 16, v242
    v_and_b32 v57, 0xffff0000, v242
    v_add_f32 v8, v8, v56
    v_fmac_f32 v9, v56, v56
    v_add_f32 v58, v58, v57
    v_fmac_f32 v59, v57, v57
    v_mfma_f32_32x32x16_bf16 v[176:191], v[84:87], v[44:47], v[176:191]
    v_lshlrev_b32 v56, 16, v243
    v_and_b32 v57, 0xffff0000, v243
    v_add_f32 v8, v8, v56
    v_fmac_f32 v9, v56, v56
    v_add_f32 v58, v58, v57
    v_fmac_f32 v59, v57, v57
    ds_read_b128 v[32:35], v3 offset:23552
    ds_read_b128 v[36:39], v3 offset:56320
    ds_read_b128 v[40:43], v5 offset:23552
    ds_read_b128 v[44:47], v5 offset:56320
    s_waitcnt vmcnt(12) lgkmcnt(4)
    v_mfma_f32_32x32x16_bf16 v[128:143], v[88:91], v[16:19], v[128:143]
    buffer_load_dwordx4 v[120:123], v3, s[8:11], s32 offen offset:2048
    v_lshlrev_b32 v56, 16, v244
    v_and_b32 v57, 0xffff0000, v244
    v_add_f32 v8, v8, v56
    v_fmac_f32 v9, v56, v56
    v_add_f32 v58, v58, v57
    v_fmac_f32 v59, v57, v57
    v_mfma_f32_32x32x16_bf16 v[144:159], v[88:91], v[20:23], v[144:159]
    s_add_u32 s57, s46, 0
    buffer_load_dwordx4 v[84:87], v11, s[48:51], s57 offen offset:2048
    v_lshlrev_b32 v56, 16, v245
    v_and_b32 v57, 0xffff0000, v245
    v_add_f32 v8, v8, v56
    v_fmac_f32 v9, v56, v56
    v_add_f32 v58, v58, v57
    v_fmac_f32 v59, v57, v57
    v_mfma_f32_32x32x16_bf16 v[160:175], v[88:91], v[24:27], v[160:175]
    v_lshlrev_b32 v56, 16, v246
    v_and_b32 v57, 0xffff0000, v246
    v_add_f32 v8, v8, v56
    v_fmac_f32 v9, v56, v56
    v_add_f32 v58, v58, v57
    v_fmac_f32 v59, v57, v57
    v_mfma_f32_32x32x16_bf16 v[176:191], v[88:91], v[28:31], v[176:191]
    v_lshlrev_b32 v56, 16, v247
    v_and_b32 v57, 0xffff0000, v247
    v_add_f32 v8, v8, v56
    v_fmac_f32 v9, v56, v56
    v_add_f32 v58, v58, v57
    v_fmac_f32 v59, v57, v57
    v_add_f32 v8, v8, v58
    v_add_f32 v9, v9, v59
    s_and_b32 s58, s22, 3
    s_lshl_b32 s58, s58, 9
    v_permlane32_swap_b32 v8, v9
    s_lshr_b32 s59, s22, 2
    s_lshl_b32 s59, s59, 3
    s_add_u32 s58, s58, s59
    s_add_u32 s58, s58, 0x20000
    v_add_f32 v8, v8, v9
    v_and_b32 v10, 31, v2
    v_lshlrev_b32 v10, 4, v10
    v_lshrrev_b32 v6, 5, v2
    v_lshl_add_u32 v6, v6, 2, v10
    v_add_u32 v6, s58, v6
    v_add_u32 v10, 0x20000, v10
    ds_write_b32 v6, v8
    s_waitcnt lgkmcnt(0)
    s_barrier
    s_waitcnt vmcnt(13) lgkmcnt(0)
    v_mfma_f32_32x32x16_bf16 v[128:143], v[92:95], v[32:35], v[128:143]
    buffer_load_dwordx4 v[124:127], v3, s[8:11], s32 offen offset:3072
    v_mfma_f32_32x32x16_bf16 v[144:159], v[92:95], v[36:39], v[144:159]
    s_add_u32 s57, s46, 0
    buffer_load_dwordx4 v[88:91], v3, s[48:51], s57 offen offset:3072
    v_mfma_f32_32x32x16_bf16 v[160:175], v[92:95], v[40:43], v[160:175]
    v_mfma_f32_32x32x16_bf16 v[176:191], v[92:95], v[44:47], v[176:191]
    ds_read_b128 v[224:227], v10 offset:0
    ds_read_b128 v[228:231], v10 offset:512
    ds_read_b128 v[232:235], v10 offset:1024
    ds_read_b128 v[236:239], v10 offset:1536
    ds_read_b128 v[192:195], v4 offset:0
    ds_read_b128 v[196:199], v4 offset:16
    ds_read_b128 v[200:203], v4 offset:32
    ds_read_b128 v[204:207], v4 offset:48
    ds_read_b128 v[208:211], v4 offset:128
    ds_read_b128 v[212:215], v4 offset:144
    ds_read_b128 v[216:219], v4 offset:160
    ds_read_b128 v[220:223], v4 offset:176
    ds_read_b128 v[16:19], v3 offset:24576
    ds_read_b128 v[20:23], v3 offset:25600
    ds_read_b128 v[24:27], v3 offset:26624
    ds_read_b128 v[28:31], v3 offset:27648
    ds_read_b128 v[32:35], v3 offset:28672
    ds_read_b128 v[36:39], v3 offset:29696
    s_lshl_b32 s31, s20, 2
    s_mul_i32 s31, s31, 114688
    s_lshl_b32 s32, s23, 10
    s_add_u32 s31, s31, s32
    s_mov_b32 s36, 0xbfb8aa3b
    s_mov_b32 s37, 0xbfb8aa3b
    s_waitcnt lgkmcnt(6)
    s_waitcnt vmcnt(1)
    ds_read_b128 v[40:43], v3 offset:30720
    s_waitcnt lgkmcnt(6)
    v_mfma_f32_32x32x16_bf16 v[128:143], v[96:99], v[16:19], v[128:143]
    v_add_f32 v224, v224, v226
    v_add_f32 v225, v225, v227
    v_add_f32 v228, v228, v230
    v_add_f32 v229, v229, v231
    v_add_f32 v232, v232, v234
    v_add_f32 v233, v233, v235
    v_add_f32 v236, v236, v238
    v_add_f32 v237, v237, v239
    v_mul_f32 v224, 0x3b000000, v224
    v_mul_f32 v225, 0x3b000000, v225
    v_mul_f32 v228, 0x3b000000, v228
    v_mul_f32 v229, 0x3b000000, v229
    ds_read_b128 v[44:47], v3 offset:31744
    s_waitcnt lgkmcnt(6)
    v_mfma_f32_32x32x16_bf16 v[128:143], v[100:103], v[20:23], v[128:143]
    v_mul_f32 v232, 0x3b000000, v232
    v_mul_f32 v233, 0x3b000000, v233
    v_mul_f32 v236, 0x3b000000, v236
    v_mul_f32 v237, 0x3b000000, v237
    v_fma_f32 v225, -v224, v224, v225
    v_max_f32 v225, 0, v225
    v_add_f32 v225, 0x3727c5ac, v225
    v_fma_f32 v229, -v228, v228, v229
    v_max_f32 v229, 0, v229
    v_add_f32 v229, 0x3727c5ac, v229
    v_fma_f32 v233, -v232, v232, v233
    v_max_f32 v233, 0, v233
    ds_read_b128 v[16:19], v3 offset:57344
    s_waitcnt lgkmcnt(6)
    v_mfma_f32_32x32x16_bf16 v[128:143], v[104:107], v[24:27], v[128:143]
    v_add_f32 v233, 0x3727c5ac, v233
    v_fma_f32 v237, -v236, v236, v237
    v_max_f32 v237, 0, v237
    v_add_f32 v237, 0x3727c5ac, v237
    v_rsq_f32 v240, v225
    v_rsq_f32 v242, v229
    v_rsq_f32 v244, v233
    v_rsq_f32 v246, v237
    v_mul_f32 v241, -v224, v240
    v_mul_f32 v243, -v228, v242
    v_mul_f32 v245, -v232, v244
    v_mul_f32 v247, -v236, v246
    s_add_u32 s57, s46, 0
    buffer_load_dwordx4 v[92:95], v11, s[48:51], s57 offen offset:3072
    s_add_u32 s57, s46, 4096
    buffer_load_dwordx4 v[48:51], v3, s[48:51], s57 offen offset:0
    s_add_u32 s57, s46, 4096
    buffer_load_dwordx4 v[52:55], v11, s[48:51], s57 offen offset:0
    ds_read_b128 v[20:23], v3 offset:58368
    s_waitcnt lgkmcnt(6)
    v_mfma_f32_32x32x16_bf16 v[128:143], v[108:111], v[28:31], v[128:143]
    s_add_u32 s57, s46, 4096
    buffer_load_dwordx4 v[56:59], v3, s[48:51], s57 offen offset:1024
    s_add_u32 s57, s46, 4096
    buffer_load_dwordx4 v[60:63], v11, s[48:51], s57 offen offset:1024
    s_add_u32 s57, s46, 4096
    buffer_load_dwordx4 v[248:251], v3, s[48:51], s57 offen offset:2048
    s_add_u32 s57, s46, 4096
    buffer_load_dwordx4 v[252:255], v11, s[48:51], s57 offen offset:2048
    ds_read_b128 v[24:27], v3 offset:59392
    s_waitcnt lgkmcnt(6)
    v_mfma_f32_32x32x16_bf16 v[128:143], v[112:115], v[32:35], v[128:143]
    ds_read_b128 v[28:31], v3 offset:60416
    s_waitcnt lgkmcnt(6)
    v_mfma_f32_32x32x16_bf16 v[128:143], v[116:119], v[36:39], v[128:143]
    ds_read_b128 v[32:35], v3 offset:61440
    s_waitcnt lgkmcnt(6)
    v_mfma_f32_32x32x16_bf16 v[128:143], v[120:123], v[40:43], v[128:143]
    ds_read_b128 v[36:39], v3 offset:62464
    s_waitcnt lgkmcnt(6)
    v_mfma_f32_32x32x16_bf16 v[128:143], v[124:127], v[44:47], v[128:143]
    ds_read_b128 v[40:43], v3 offset:63488
    s_waitcnt lgkmcnt(6)
    v_mfma_f32_32x32x16_bf16 v[144:159], v[96:99], v[16:19], v[144:159]
    ds_read_b128 v[44:47], v3 offset:64512
    s_waitcnt lgkmcnt(6)
    v_mfma_f32_32x32x16_bf16 v[144:159], v[100:103], v[20:23], v[144:159]
    ds_read_b128 v[16:19], v5 offset:24576
    s_waitcnt lgkmcnt(6)
    v_mfma_f32_32x32x16_bf16 v[144:159], v[104:107], v[24:27], v[144:159]
    s_nop 3
    v_fma_f32 v128, v128, v240, v208
    v_fma_f32 v129, v129, v240, v209
    v_fma_f32 v130, v130, v240, v210
    v_fma_f32 v131, v131, v240, v211
    v_fma_f32 v132, v132, v240, v212
    v_fma_f32 v133, v133, v240, v213
    v_fma_f32 v134, v134, v240, v214
    v_fma_f32 v135, v135, v240, v215
    v_fma_f32 v136, v136, v240, v216
    v_fma_f32 v137, v137, v240, v217
    v_fma_f32 v138, v138, v240, v218
    v_fma_f32 v139, v139, v240, v219
    v_fma_f32 v140, v140, v240, v220
    v_fma_f32 v141, v141, v240, v221
    v_fma_f32 v142, v142, v240, v222
    ds_read_b128 v[20:23], v5 offset:25600
    s_waitcnt lgkmcnt(6)
    v_mfma_f32_32x32x16_bf16 v[144:159], v[108:111], v[28:31], v[144:159]
    v_fma_f32 v143, v143, v240, v223
    v_fmac_f32 v128, v192, v241
    v_fmac_f32 v129, v193, v241
    v_fmac_f32 v130, v194, v241
    v_fmac_f32 v131, v195, v241
    v_fmac_f32 v132, v196, v241
    v_fmac_f32 v133, v197, v241
    v_fmac_f32 v134, v198, v241
    v_fmac_f32 v135, v199, v241
    v_fmac_f32 v136, v200, v241
    v_fmac_f32 v137, v201, v241
    v_fmac_f32 v138, v202, v241
    v_fmac_f32 v139, v203, v241
    v_fmac_f32 v140, v204, v241
    v_fmac_f32 v141, v205, v241
    ds_read_b128 v[24:27], v5 offset:26624
    s_waitcnt lgkmcnt(6)
    v_mfma_f32_32x32x16_bf16 v[144:159], v[112:115], v[32:35], v[144:159]
    v_fmac_f32 v142, v206, v241
    v_fmac_f32 v143, v207, v241
    v_mul_f32 v224, 0xbfb8aa3b, v128
    v_mul_f32 v225, 0xbfb8aa3b, v129
    v_mul_f32 v226, 0xbfb8aa3b, v130
    v_mul_f32 v227, 0xbfb8aa3b, v131
    v_mul_f32 v228, 0xbfb8aa3b, v136
    v_mul_f32 v229, 0xbfb8aa3b, v137
    v_mul_f32 v230, 0xbfb8aa3b, v138
    v_mul_f32 v231, 0xbfb8aa3b, v139
    v_exp_f32 v224, v224
    v_exp_f32 v225, v225
    v_exp_f32 v226, v226
    v_exp_f32 v227, v227
    v_exp_f32 v228, v228
    ds_read_b128 v[28:31], v5 offset:27648
    s_waitcnt lgkmcnt(6)
    v_mfma_f32_32x32x16_bf16 v[144:159], v[116:119], v[36:39], v[144:159]
    v_exp_f32 v229, v229
    v_exp_f32 v230, v230
    v_exp_f32 v231, v231
    v_mul_f32 v232, v128, v132
    v_mul_f32 v233, v129, v133
    v_mul_f32 v234, v130, v134
    v_mul_f32 v235, v131, v135
    v_mul_f32 v236, v136, v140
    v_mul_f32 v237, v137, v141
    v_mul_f32 v238, v138, v142
    v_mul_f32 v239, v139, v143
    v_add_f32 v224, 1.0, v224
    v_add_f32 v225, 1.0, v225
    v_add_f32 v226, 1.0, v226
    v_add_f32 v227, 1.0, v227
    ds_read_b128 v[32:35], v5 offset:28672
    s_waitcnt lgkmcnt(6)
    v_mfma_f32_32x32x16_bf16 v[144:159], v[120:123], v[40:43], v[144:159]
    v_add_f32 v228, 1.0, v228
    v_add_f32 v229, 1.0, v229
    v_add_f32 v230, 1.0, v230
    v_add_f32 v231, 1.0, v231
    v_rcp_f32 v224, v224
    v_rcp_f32 v225, v225
    v_rcp_f32 v226, v226
    v_rcp_f32 v227, v227
    v_rcp_f32 v228, v228
    v_rcp_f32 v229, v229
    v_rcp_f32 v230, v230
    v_rcp_f32 v231, v231
    v_mul_f32 v232, v232, v224
    v_mul_f32 v233, v233, v225
    v_mul_f32 v234, v234, v226
    ds_read_b128 v[36:39], v5 offset:29696
    s_waitcnt lgkmcnt(6)
    v_mfma_f32_32x32x16_bf16 v[144:159], v[124:127], v[44:47], v[144:159]
    v_mul_f32 v235, v235, v227
    v_mul_f32 v236, v236, v228
    v_mul_f32 v237, v237, v229
    v_mul_f32 v238, v238, v230
    v_mul_f32 v239, v239, v231
    v_cvt_pk_bf16_f32 v128, v232, v233
    v_cvt_pk_bf16_f32 v129, v234, v235
    v_cvt_pk_bf16_f32 v130, v236, v237
    v_cvt_pk_bf16_f32 v131, v238, v239
    s_add_u32 s32, s31, 0
    buffer_store_dwordx4 v[128:131], v3, s[12:15], s32 offen sc1
    s_add_u32 s57, s46, 4096
    buffer_load_dwordx4 v[128:131], v3, s[48:51], s57 offen offset:3072
    s_add_u32 s57, s46, 4096
    buffer_load_dwordx4 v[132:135], v11, s[48:51], s57 offen offset:3072
    s_add_u32 s57, s46, 8192
    buffer_load_dwordx4 v[136:139], v3, s[48:51], s57 offen offset:0
    s_add_u32 s57, s46, 8192
    buffer_load_dwordx4 v[140:143], v11, s[48:51], s57 offen offset:0
    ds_read_b128 v[40:43], v5 offset:30720
    s_waitcnt lgkmcnt(6)
    v_mfma_f32_32x32x16_bf16 v[160:175], v[96:99], v[16:19], v[160:175]
    ds_read_b128 v[44:47], v5 offset:31744
    s_waitcnt lgkmcnt(6)
    v_mfma_f32_32x32x16_bf16 v[160:175], v[100:103], v[20:23], v[160:175]
    ds_read_b128 v[16:19], v5 offset:57344
    s_waitcnt lgkmcnt(6)
    v_mfma_f32_32x32x16_bf16 v[160:175], v[104:107], v[24:27], v[160:175]
    s_nop 3
    v_fma_f32 v144, v144, v242, v208
    v_fma_f32 v145, v145, v242, v209
    v_fma_f32 v146, v146, v242, v210
    v_fma_f32 v147, v147, v242, v211
    v_fma_f32 v148, v148, v242, v212
    v_fma_f32 v149, v149, v242, v213
    v_fma_f32 v150, v150, v242, v214
    v_fma_f32 v151, v151, v242, v215
    v_fma_f32 v152, v152, v242, v216
    v_fma_f32 v153, v153, v242, v217
    v_fma_f32 v154, v154, v242, v218
    v_fma_f32 v155, v155, v242, v219
    v_fma_f32 v156, v156, v242, v220
    v_fma_f32 v157, v157, v242, v221
    v_fma_f32 v158, v158, v242, v222
    ds_read_b128 v[20:23], v5 offset:58368
    s_waitcnt lgkmcnt(6)
    v_mfma_f32_32x32x16_bf16 v[160:175], v[108:111], v[28:31], v[160:175]
    v_fma_f32 v159, v159, v242, v223
    v_fmac_f32 v144, v192, v243
    v_fmac_f32 v145, v193, v243
    v_fmac_f32 v146, v194, v243
    v_fmac_f32 v147, v195, v243
    v_fmac_f32 v148, v196, v243
    v_fmac_f32 v149, v197, v243
    v_fmac_f32 v150, v198, v243
    v_fmac_f32 v151, v199, v243
    v_fmac_f32 v152, v200, v243
    v_fmac_f32 v153, v201, v243
    v_fmac_f32 v154, v202, v243
    v_fmac_f32 v155, v203, v243
    v_fmac_f32 v156, v204, v243
    v_fmac_f32 v157, v205, v243
    ds_read_b128 v[24:27], v5 offset:59392
    s_waitcnt lgkmcnt(6)
    v_mfma_f32_32x32x16_bf16 v[160:175], v[112:115], v[32:35], v[160:175]
    v_fmac_f32 v158, v206, v243
    v_fmac_f32 v159, v207, v243
    v_mul_f32 v224, 0xbfb8aa3b, v144
    v_mul_f32 v225, 0xbfb8aa3b, v145
    v_mul_f32 v226, 0xbfb8aa3b, v146
    v_mul_f32 v227, 0xbfb8aa3b, v147
    v_mul_f32 v228, 0xbfb8aa3b, v152
    v_mul_f32 v229, 0xbfb8aa3b, v153
    v_mul_f32 v230, 0xbfb8aa3b, v154
    v_mul_f32 v231, 0xbfb8aa3b, v155
    v_exp_f32 v224, v224
    v_exp_f32 v225, v225
    v_exp_f32 v226, v226
    v_exp_f32 v227, v227
    v_exp_f32 v228, v228
    ds_read_b128 v[28:31], v5 offset:60416
    s_waitcnt lgkmcnt(6)
    v_mfma_f32_32x32x16_bf16 v[160:175], v[116:119], v[36:39], v[160:175]
    v_exp_f32 v229, v229
    v_exp_f32 v230, v230
    v_exp_f32 v231, v231
    v_mul_f32 v232, v144, v148
    v_mul_f32 v233, v145, v149
    v_mul_f32 v234, v146, v150
    v_mul_f32 v235, v147, v151
    v_mul_f32 v236, v152, v156
    v_mul_f32 v237, v153, v157
    v_mul_f32 v238, v154, v158
    v_mul_f32 v239, v155, v159
    v_add_f32 v224, 1.0, v224
    v_add_f32 v225, 1.0, v225
    v_add_f32 v226, 1.0, v226
    v_add_f32 v227, 1.0, v227
    ds_read_b128 v[32:35], v5 offset:61440
    s_waitcnt lgkmcnt(6)
    v_mfma_f32_32x32x16_bf16 v[160:175], v[120:123], v[40:43], v[160:175]
    v_add_f32 v228, 1.0, v228
    v_add_f32 v229, 1.0, v229
    v_add_f32 v230, 1.0, v230
    v_add_f32 v231, 1.0, v231
    v_rcp_f32 v224, v224
    v_rcp_f32 v225, v225
    v_rcp_f32 v226, v226
    v_rcp_f32 v227, v227
    v_rcp_f32 v228, v228
    v_rcp_f32 v229, v229
    v_rcp_f32 v230, v230
    v_rcp_f32 v231, v231
    v_mul_f32 v232, v232, v224
    v_mul_f32 v233, v233, v225
    v_mul_f32 v234, v234, v226
    ds_read_b128 v[36:39], v5 offset:62464
    s_waitcnt lgkmcnt(6)
    v_mfma_f32_32x32x16_bf16 v[160:175], v[124:127], v[44:47], v[160:175]
    v_mul_f32 v235, v235, v227
    v_mul_f32 v236, v236, v228
    v_mul_f32 v237, v237, v229
    v_mul_f32 v238, v238, v230
    v_mul_f32 v239, v239, v231
    v_cvt_pk_bf16_f32 v144, v232, v233
    v_cvt_pk_bf16_f32 v145, v234, v235
    v_cvt_pk_bf16_f32 v146, v236, v237
    v_cvt_pk_bf16_f32 v147, v238, v239
    s_add_u32 s32, s31, 114688
    buffer_store_dwordx4 v[144:147], v3, s[12:15], s32 offen sc1
    s_add_u32 s57, s46, 8192
    buffer_load_dwordx4 v[144:147], v3, s[48:51], s57 offen offset:1024
    s_add_u32 s57, s46, 8192
    buffer_load_dwordx4 v[148:151], v11, s[48:51], s57 offen offset:1024
    s_add_u32 s57, s46, 8192
    buffer_load_dwordx4 v[152:155], v3, s[48:51], s57 offen offset:2048
    s_add_u32 s57, s46, 8192
    buffer_load_dwordx4 v[156:159], v11, s[48:51], s57 offen offset:2048
    ds_read_b128 v[40:43], v5 offset:63488
    s_waitcnt lgkmcnt(6)
    v_mfma_f32_32x32x16_bf16 v[176:191], v[96:99], v[16:19], v[176:191]
    ds_read_b128 v[44:47], v5 offset:64512
    s_waitcnt lgkmcnt(6)
    v_mfma_f32_32x32x16_bf16 v[176:191], v[100:103], v[20:23], v[176:191]
    s_waitcnt lgkmcnt(5)
    v_mfma_f32_32x32x16_bf16 v[176:191], v[104:107], v[24:27], v[176:191]
    s_nop 3
    v_fma_f32 v160, v160, v244, v208
    v_fma_f32 v161, v161, v244, v209
    v_fma_f32 v162, v162, v244, v210
    v_fma_f32 v163, v163, v244, v211
    v_fma_f32 v164, v164, v244, v212
    v_fma_f32 v165, v165, v244, v213
    v_fma_f32 v166, v166, v244, v214
    v_fma_f32 v167, v167, v244, v215
    v_fma_f32 v168, v168, v244, v216
    v_fma_f32 v169, v169, v244, v217
    v_fma_f32 v170, v170, v244, v218
    v_fma_f32 v171, v171, v244, v219
    v_fma_f32 v172, v172, v244, v220
    v_fma_f32 v173, v173, v244, v221
    v_fma_f32 v174, v174, v244, v222
    s_waitcnt lgkmcnt(4)
    v_mfma_f32_32x32x16_bf16 v[176:191], v[108:111], v[28:31], v[176:191]
    v_fma_f32 v175, v175, v244, v223
    v_fmac_f32 v160, v192, v245
    v_fmac_f32 v161, v193, v245
    v_fmac_f32 v162, v194, v245
    v_fmac_f32 v163, v195, v245
    v_fmac_f32 v164, v196, v245
    v_fmac_f32 v165, v197, v245
    v_fmac_f32 v166, v198, v245
    v_fmac_f32 v167, v199, v245
    v_fmac_f32 v168, v200, v245
    v_fmac_f32 v169, v201, v245
    v_fmac_f32 v170, v202, v245
    v_fmac_f32 v171, v203, v245
    v_fmac_f32 v172, v204, v245
    v_fmac_f32 v173, v205, v245
    s_waitcnt lgkmcnt(3)
    v_mfma_f32_32x32x16_bf16 v[176:191], v[112:115], v[32:35], v[176:191]
    v_fmac_f32 v174, v206, v245
    v_fmac_f32 v175, v207, v245
    v_mul_f32 v224, 0xbfb8aa3b, v160
    v_mul_f32 v225, 0xbfb8aa3b, v161
    v_mul_f32 v226, 0xbfb8aa3b, v162
    v_mul_f32 v227, 0xbfb8aa3b, v163
    v_mul_f32 v228, 0xbfb8aa3b, v168
    v_mul_f32 v229, 0xbfb8aa3b, v169
    v_mul_f32 v230, 0xbfb8aa3b, v170
    v_mul_f32 v231, 0xbfb8aa3b, v171
    v_exp_f32 v224, v224
    v_exp_f32 v225, v225
    v_exp_f32 v226, v226
    v_exp_f32 v227, v227
    v_exp_f32 v228, v228
    s_waitcnt lgkmcnt(2)
    v_mfma_f32_32x32x16_bf16 v[176:191], v[116:119], v[36:39], v[176:191]
    v_exp_f32 v229, v229
    v_exp_f32 v230, v230
    v_exp_f32 v231, v231
    v_mul_f32 v232, v160, v164
    v_mul_f32 v233, v161, v165
    v_mul_f32 v234, v162, v166
    v_mul_f32 v235, v163, v167
    v_mul_f32 v236, v168, v172
    v_mul_f32 v237, v169, v173
    v_mul_f32 v238, v170, v174
    v_mul_f32 v239, v171, v175
    v_add_f32 v224, 1.0, v224
    v_add_f32 v225, 1.0, v225
    v_add_f32 v226, 1.0, v226
    v_add_f32 v227, 1.0, v227
    s_waitcnt lgkmcnt(1)
    v_mfma_f32_32x32x16_bf16 v[176:191], v[120:123], v[40:43], v[176:191]
    v_add_f32 v228, 1.0, v228
    v_add_f32 v229, 1.0, v229
    v_add_f32 v230, 1.0, v230
    v_add_f32 v231, 1.0, v231
    v_rcp_f32 v224, v224
    v_rcp_f32 v225, v225
    v_rcp_f32 v226, v226
    v_rcp_f32 v227, v227
    v_rcp_f32 v228, v228
    v_rcp_f32 v229, v229
    v_rcp_f32 v230, v230
    v_rcp_f32 v231, v231
    v_mul_f32 v232, v232, v224
    v_mul_f32 v233, v233, v225
    v_mul_f32 v234, v234, v226
    s_waitcnt lgkmcnt(0)
    v_mfma_f32_32x32x16_bf16 v[176:191], v[124:127], v[44:47], v[176:191]
    v_mul_f32 v235, v235, v227
    v_mul_f32 v236, v236, v228
    v_mul_f32 v237, v237, v229
    v_mul_f32 v238, v238, v230
    v_mul_f32 v239, v239, v231
    v_cvt_pk_bf16_f32 v160, v232, v233
    v_cvt_pk_bf16_f32 v161, v234, v235
    v_cvt_pk_bf16_f32 v162, v236, v237
    v_cvt_pk_bf16_f32 v163, v238, v239
    s_add_u32 s32, s31, 229376
    buffer_store_dwordx4 v[160:163], v3, s[12:15], s32 offen sc1
    s_add_u32 s57, s46, 8192
    buffer_load_dwordx4 v[160:163], v3, s[48:51], s57 offen offset:3072
    s_add_u32 s57, s46, 8192
    buffer_load_dwordx4 v[164:167], v11, s[48:51], s57 offen offset:3072
    s_add_u32 s57, s46, 12288
    buffer_load_dwordx4 v[168:171], v3, s[48:51], s57 offen offset:0
    s_add_u32 s57, s46, 12288
    buffer_load_dwordx4 v[172:175], v11, s[48:51], s57 offen offset:0
    s_nop 7
    s_nop 3
    v_fma_f32 v176, v176, v246, v208
    v_fma_f32 v177, v177, v246, v209
    v_fma_f32 v178, v178, v246, v210
    v_fma_f32 v179, v179, v246, v211
    v_fma_f32 v180, v180, v246, v212
    v_fma_f32 v181, v181, v246, v213
    v_fma_f32 v182, v182, v246, v214
    v_fma_f32 v183, v183, v246, v215
    v_fma_f32 v184, v184, v246, v216
    v_fma_f32 v185, v185, v246, v217
    v_fma_f32 v186, v186, v246, v218
    v_fma_f32 v187, v187, v246, v219
    v_fma_f32 v188, v188, v246, v220
    v_fma_f32 v189, v189, v246, v221
    v_fma_f32 v190, v190, v246, v222
    v_fma_f32 v191, v191, v246, v223
    v_fmac_f32 v176, v192, v247
    v_fmac_f32 v177, v193, v247
    v_fmac_f32 v178, v194, v247
    v_fmac_f32 v179, v195, v247
    v_fmac_f32 v180, v196, v247
    v_fmac_f32 v181, v197, v247
    v_fmac_f32 v182, v198, v247
    v_fmac_f32 v183, v199, v247
    v_fmac_f32 v184, v200, v247
    v_fmac_f32 v185, v201, v247
    v_fmac_f32 v186, v202, v247
    v_fmac_f32 v187, v203, v247
    v_fmac_f32 v188, v204, v247
    v_fmac_f32 v189, v205, v247
    v_fmac_f32 v190, v206, v247
    v_fmac_f32 v191, v207, v247
    v_mul_f32 v224, 0xbfb8aa3b, v176
    v_mul_f32 v225, 0xbfb8aa3b, v177
    v_mul_f32 v226, 0xbfb8aa3b, v178
    v_mul_f32 v227, 0xbfb8aa3b, v179
    v_mul_f32 v228, 0xbfb8aa3b, v184
    v_mul_f32 v229, 0xbfb8aa3b, v185
    v_mul_f32 v230, 0xbfb8aa3b, v186
    v_mul_f32 v231, 0xbfb8aa3b, v187
    v_exp_f32 v224, v224
    v_exp_f32 v225, v225
    v_exp_f32 v226, v226
    v_exp_f32 v227, v227
    v_exp_f32 v228, v228
    v_exp_f32 v229, v229
    v_exp_f32 v230, v230
    v_exp_f32 v231, v231
    v_mul_f32 v232, v176, v180
    v_mul_f32 v233, v177, v181
    v_mul_f32 v234, v178, v182
    v_mul_f32 v235, v179, v183
    v_mul_f32 v236, v184, v188
    v_mul_f32 v237, v185, v189
    v_mul_f32 v238, v186, v190
    v_mul_f32 v239, v187, v191
    v_add_f32 v224, 1.0, v224
    v_add_f32 v225, 1.0, v225
    v_add_f32 v226, 1.0, v226
    v_add_f32 v227, 1.0, v227
    v_add_f32 v228, 1.0, v228
    v_add_f32 v229, 1.0, v229
    v_add_f32 v230, 1.0, v230
    v_add_f32 v231, 1.0, v231
    v_rcp_f32 v224, v224
    v_rcp_f32 v225, v225
    v_rcp_f32 v226, v226
    v_rcp_f32 v227, v227
    v_rcp_f32 v228, v228
    v_rcp_f32 v229, v229
    v_rcp_f32 v230, v230
    v_rcp_f32 v231, v231
    v_mul_f32 v232, v232, v224
    v_mul_f32 v233, v233, v225
    v_mul_f32 v234, v234, v226
    v_mul_f32 v235, v235, v227
    v_mul_f32 v236, v236, v228
    v_mul_f32 v237, v237, v229
    v_mul_f32 v238, v238, v230
    v_mul_f32 v239, v239, v231
    v_cvt_pk_bf16_f32 v176, v232, v233
    v_cvt_pk_bf16_f32 v177, v234, v235
    v_cvt_pk_bf16_f32 v178, v236, v237
    v_cvt_pk_bf16_f32 v179, v238, v239
    s_add_u32 s32, s31, 344064
    buffer_store_dwordx4 v[176:179], v3, s[12:15], s32 offen sc1
    s_add_u32 s57, s46, 12288
    buffer_load_dwordx4 v[176:179], v3, s[48:51], s57 offen offset:1024
    s_add_u32 s57, s46, 12288
    buffer_load_dwordx4 v[180:183], v11, s[48:51], s57 offen offset:1024
    v_mov_b32 v14, 1
    s_mov_b64 exec, 1
    s_waitcnt vmcnt(2)
    ds_add_rtn_u32 v15, v1, v14
    v_mov_b32 v12, 0
    s_lshl_b32 s31, s20, 8
    s_waitcnt lgkmcnt(0)
    v_readfirstlane_b32 s32, v15
    s_cmp_lg_u32 s32, 7
    s_cbranch_scc1 KC_NA
    buffer_atomic_add v14, v12, s[52:55], s31 offen sc1
KC_NA:
    s_mov_b64 exec, -1
    s_branch KC_P3
KC_P2:
    s_add_u32 s57, s46, 0
    buffer_load_dwordx4 v[64:67], v3, s[48:51], s57 offen offset:0
    s_add_u32 s57, s46, 0
    buffer_load_dwordx4 v[68:71], v11, s[48:51], s57 offen offset:0
    s_add_u32 s57, s46, 0
    buffer_load_dwordx4 v[72:75], v3, s[48:51], s57 offen offset:1024
    s_add_u32 s57, s46, 0
    buffer_load_dwordx4 v[76:79], v11, s[48:51], s57 offen offset:1024
    s_add_u32 s57, s46, 0
    buffer_load_dwordx4 v[80:83], v3, s[48:51], s57 offen offset:2048
    s_add_u32 s57, s46, 0
    buffer_load_dwordx4 v[84:87], v11, s[48:51], s57 offen offset:2048
    s_add_u32 s57, s46, 0
    buffer_load_dwordx4 v[88:91], v3, s[48:51], s57 offen offset:3072
    s_add_u32 s57, s46, 0
    buffer_load_dwordx4 v[92:95], v11, s[48:51], s57 offen offset:3072
    s_add_u32 s57, s46, 4096
    buffer_load_dwordx4 v[48:51], v3, s[48:51], s57 offen offset:0
    s_add_u32 s57, s46, 4096
    buffer_load_dwordx4 v[52:55], v11, s[48:51], s57 offen offset:0
    s_add_u32 s57, s46, 4096
    buffer_load_dwordx4 v[56:59], v3, s[48:51], s57 offen offset:1024
    s_add_u32 s57, s46, 4096
    buffer_load_dwordx4 v[60:63], v11, s[48:51], s57 offen offset:1024
    s_add_u32 s57, s46, 4096
    buffer_load_dwordx4 v[248:251], v3, s[48:51], s57 offen offset:2048
    s_add_u32 s57, s46, 4096
    buffer_load_dwordx4 v[252:255], v11, s[48:51], s57 offen offset:2048
    s_add_u32 s57, s46, 4096
    buffer_load_dwordx4 v[128:131], v3, s[48:51], s57 offen offset:3072
    s_add_u32 s57, s46, 4096
    buffer_load_dwordx4 v[132:135], v11, s[48:51], s57 offen offset:3072
    s_add_u32 s57, s46, 8192
    buffer_load_dwordx4 v[136:139], v3, s[48:51], s57 offen offset:0
    s_add_u32 s57, s46, 8192
    buffer_load_dwordx4 v[140:143], v11, s[48:51], s57 offen offset:0
    s_add_u32 s57, s46, 8192
    buffer_load_dwordx4 v[144:147], v3, s[48:51], s57 offen offset:1024
    s_add_u32 s57, s46, 8192
    buffer_load_dwordx4 v[148:151], v11, s[48:51], s57 offen offset:1024
    s_add_u32 s57, s46, 8192
    buffer_load_dwordx4 v[152:155], v3, s[48:51], s57 offen offset:2048
    s_add_u32 s57, s46, 8192
    buffer_load_dwordx4 v[156:159], v11, s[48:51], s57 offen offset:2048
    s_add_u32 s57, s46, 8192
    buffer_load_dwordx4 v[160:163], v3, s[48:51], s57 offen offset:3072
    s_add_u32 s57, s46, 8192
    buffer_load_dwordx4 v[164:167], v11, s[48:51], s57 offen offset:3072
    s_add_u32 s57, s46, 12288
    buffer_load_dwordx4 v[168:171], v3, s[48:51], s57 offen offset:0
    s_add_u32 s57, s46, 12288
    buffer_load_dwordx4 v[172:175], v11, s[48:51], s57 offen offset:0
    s_add_u32 s57, s46, 12288
    buffer_load_dwordx4 v[176:179], v3, s[48:51], s57 offen offset:1024
    s_add_u32 s57, s46, 12288
    buffer_load_dwordx4 v[180:183], v11, s[48:51], s57 offen offset:1024
KC_P3:
    s_cmp_lg_u32 s22, 0
    s_cbranch_scc1 KC_NP
    v_mov_b32 v14, 0
    s_lshr_b32 s31, s44, 1
    s_lshl_b32 s31, s31, 8
KC_POLL:
    s_sleep 6
    buffer_load_dword v15, v14, s[52:55], s31 offen sc1
    s_waitcnt vmcnt(0)
    v_readfirstlane_b32 s32, v15
    s_cmp_lt_u32 s32, 14
    s_cbranch_scc1 KC_POLL
KC_NP:
    s_waitcnt vmcnt(0)
    s_barrier
    s_add_u32 s57, s56, 0
    buffer_load_dwordx4 v[192:195], v3, s[12:15], s57 offen offset:0 sc1
    buffer_load_dwordx4 v[196:199], v11, s[12:15], s57 offen offset:0 sc1
    buffer_load_dwordx4 v[200:203], v3, s[12:15], s57 offen offset:1024 sc1
    buffer_load_dwordx4 v[204:207], v11, s[12:15], s57 offen offset:1024 sc1
    buffer_load_dwordx4 v[208:211], v3, s[12:15], s57 offen offset:2048 sc1
    buffer_load_dwordx4 v[212:215], v11, s[12:15], s57 offen offset:2048 sc1
    buffer_load_dwordx4 v[216:219], v3, s[12:15], s57 offen offset:3072 sc1
    buffer_load_dwordx4 v[220:223], v11, s[12:15], s57 offen offset:3072 sc1
    s_add_u32 s57, s56, 4096
    buffer_load_dwordx4 v[224:227], v3, s[12:15], s57 offen offset:0 sc1
    buffer_load_dwordx4 v[228:231], v11, s[12:15], s57 offen offset:0 sc1
    buffer_load_dwordx4 v[232:235], v3, s[12:15], s57 offen offset:1024 sc1
    buffer_load_dwordx4 v[236:239], v11, s[12:15], s57 offen offset:1024 sc1
    buffer_load_dwordx4 v[240:243], v3, s[12:15], s57 offen offset:2048 sc1
    buffer_load_dwordx4 v[244:247], v11, s[12:15], s57 offen offset:2048 sc1
    s_mov_b32 s42, 2097152
    s_mov_b32 s43, 0x00020000
    s_add_u32 s24, s16, 131072
    s_addc_u32 s25, s17, 0
    s_mov_b32 s26, 49152
    s_mov_b32 s27, 0x00020000
    s_bfe_u32 s35, s22, 0x10001
    s_lshr_b32 s36, s22, 2
    s_and_b32 s34, s22, 1
    s_lshl_b32 s37, s44, 1
    s_add_u32 s37, s37, s36
    s_lshl_b32 s38, s45, 2
    s_lshl_b32 s35, s35, 1
    s_add_u32 s38, s38, s35
    s_add_u32 s38, s38, s34
    s_lshl_b32 s39, s37, 15
    s_lshl_b32 s33, s38, 10
    s_add_u32 s39, s39, s33
    v_lshrrev_b32 v5, 5, v2
    v_lshlrev_b32 v4, 5, v5
    s_lshl_b32 s33, s38, 6
    s_add_u32 s33, s33, 10240
    s_waitcnt vmcnt(12)
    v_mfma_f32_32x32x16_bf16 v[16:31], v[64:67], v[192:195], 0
    v_mfma_f32_32x32x16_bf16 v[32:47], v[68:71], v[192:195], 0
    v_mfma_f32_32x32x16_bf16 v[96:111], v[64:67], v[196:199], 0
    v_mfma_f32_32x32x16_bf16 v[112:127], v[68:71], v[196:199], 0
    buffer_load_dwordx4 v[192:195], v3, s[12:15], s57 offen offset:3072 sc1
    buffer_load_dwordx4 v[196:199], v11, s[12:15], s57 offen offset:3072 sc1
    s_waitcnt vmcnt(12)
    v_mfma_f32_32x32x16_bf16 v[16:31], v[72:75], v[200:203], v[16:31]
    v_mfma_f32_32x32x16_bf16 v[32:47], v[76:79], v[200:203], v[32:47]
    v_mfma_f32_32x32x16_bf16 v[96:111], v[72:75], v[204:207], v[96:111]
    v_mfma_f32_32x32x16_bf16 v[112:127], v[76:79], v[204:207], v[112:127]
    s_add_u32 s57, s56, 8192
    buffer_load_dwordx4 v[200:203], v3, s[12:15], s57 offen offset:0 sc1
    buffer_load_dwordx4 v[204:207], v11, s[12:15], s57 offen offset:0 sc1
    s_waitcnt vmcnt(12)
    v_mfma_f32_32x32x16_bf16 v[16:31], v[80:83], v[208:211], v[16:31]
    v_mfma_f32_32x32x16_bf16 v[32:47], v[84:87], v[208:211], v[32:47]
    v_mfma_f32_32x32x16_bf16 v[96:111], v[80:83], v[212:215], v[96:111]
    v_mfma_f32_32x32x16_bf16 v[112:127], v[84:87], v[212:215], v[112:127]
    buffer_load_dwordx4 v[208:211], v3, s[12:15], s57 offen offset:1024 sc1
    buffer_load_dwordx4 v[212:215], v11, s[12:15], s57 offen offset:1024 sc1
    s_waitcnt vmcnt(12)
    v_mfma_f32_32x32x16_bf16 v[16:31], v[88:91], v[216:219], v[16:31]
    v_mfma_f32_32x32x16_bf16 v[32:47], v[92:95], v[216:219], v[32:47]
    v_mfma_f32_32x32x16_bf16 v[96:111], v[88:91], v[220:223], v[96:111]
    v_mfma_f32_32x32x16_bf16 v[112:127], v[92:95], v[220:223], v[112:127]
    buffer_load_dwordx4 v[216:219], v3, s[12:15], s57 offen offset:2048 sc1
    buffer_load_dwordx4 v[220:223], v11, s[12:15], s57 offen offset:2048 sc1
    s_waitcnt vmcnt(12)
    v_mfma_f32_32x32x16_bf16 v[16:31], v[48:51], v[224:227], v[16:31]
    v_mfma_f32_32x32x16_bf16 v[32:47], v[52:55], v[224:227], v[32:47]
    v_mfma_f32_32x32x16_bf16 v[96:111], v[48:51], v[228:231], v[96:111]
    v_mfma_f32_32x32x16_bf16 v[112:127], v[52:55], v[228:231], v[112:127]
    buffer_load_dwordx4 v[224:227], v3, s[12:15], s57 offen offset:3072 sc1
    buffer_load_dwordx4 v[228:231], v11, s[12:15], s57 offen offset:3072 sc1
    s_waitcnt vmcnt(12)
    v_mfma_f32_32x32x16_bf16 v[16:31], v[56:59], v[232:235], v[16:31]
    v_mfma_f32_32x32x16_bf16 v[32:47], v[60:63], v[232:235], v[32:47]
    v_mfma_f32_32x32x16_bf16 v[96:111], v[56:59], v[236:239], v[96:111]
    v_mfma_f32_32x32x16_bf16 v[112:127], v[60:63], v[236:239], v[112:127]
    s_add_u32 s57, s56, 12288
    buffer_load_dwordx4 v[232:235], v3, s[12:15], s57 offen offset:0 sc1
    buffer_load_dwordx4 v[236:239], v11, s[12:15], s57 offen offset:0 sc1
    s_waitcnt vmcnt(12)
    v_mfma_f32_32x32x16_bf16 v[16:31], v[248:251], v[240:243], v[16:31]
    v_mfma_f32_32x32x16_bf16 v[32:47], v[252:255], v[240:243], v[32:47]
    v_mfma_f32_32x32x16_bf16 v[96:111], v[248:251], v[244:247], v[96:111]
    v_mfma_f32_32x32x16_bf16 v[112:127], v[252:255], v[244:247], v[112:127]
    buffer_load_dwordx4 v[240:243], v3, s[12:15], s57 offen offset:1024 sc1
    buffer_load_dwordx4 v[244:247], v11, s[12:15], s57 offen offset:1024 sc1
    s_waitcnt vmcnt(12)
    v_mfma_f32_32x32x16_bf16 v[16:31], v[128:131], v[192:195], v[16:31]
    v_mfma_f32_32x32x16_bf16 v[32:47], v[132:135], v[192:195], v[32:47]
    v_mfma_f32_32x32x16_bf16 v[96:111], v[128:131], v[196:199], v[96:111]
    v_mfma_f32_32x32x16_bf16 v[112:127], v[132:135], v[196:199], v[112:127]
    buffer_load_dwordx4 v[64:67], v3, s[4:7], s39 offen
    buffer_load_dwordx4 v[72:75], v4, s[24:27], s33 offen offset:0
    buffer_load_dwordx4 v[76:79], v4, s[24:27], s33 offen offset:16
    s_add_u32 s33, s33, 12288
    buffer_load_dwordx4 v[80:83], v4, s[24:27], s33 offen offset:0
    buffer_load_dwordx4 v[84:87], v4, s[24:27], s33 offen offset:16
    s_add_u32 s33, s33, 12288
    buffer_load_dwordx4 v[88:91], v4, s[24:27], s33 offen offset:0
    buffer_load_dwordx4 v[92:95], v4, s[24:27], s33 offen offset:16
    s_add_u32 s33, s33, 12288
    buffer_load_dwordx4 v[48:51], v4, s[24:27], s33 offen offset:0
    buffer_load_dwordx4 v[52:55], v4, s[24:27], s33 offen offset:16
    s_add_u32 s33, s33, 12288
    s_waitcnt vmcnt(19)
    v_mfma_f32_32x32x16_bf16 v[16:31], v[136:139], v[200:203], v[16:31]
    v_mfma_f32_32x32x16_bf16 v[32:47], v[140:143], v[200:203], v[32:47]
    v_mfma_f32_32x32x16_bf16 v[96:111], v[136:139], v[204:207], v[96:111]
    v_mfma_f32_32x32x16_bf16 v[112:127], v[140:143], v[204:207], v[112:127]
    s_waitcnt vmcnt(17)
    v_mfma_f32_32x32x16_bf16 v[16:31], v[144:147], v[208:211], v[16:31]
    v_mfma_f32_32x32x16_bf16 v[32:47], v[148:151], v[208:211], v[32:47]
    v_mfma_f32_32x32x16_bf16 v[96:111], v[144:147], v[212:215], v[96:111]
    v_mfma_f32_32x32x16_bf16 v[112:127], v[148:151], v[212:215], v[112:127]
    s_waitcnt vmcnt(15)
    v_mfma_f32_32x32x16_bf16 v[16:31], v[152:155], v[216:219], v[16:31]
    v_mfma_f32_32x32x16_bf16 v[32:47], v[156:159], v[216:219], v[32:47]
    v_mfma_f32_32x32x16_bf16 v[96:111], v[152:155], v[220:223], v[96:111]
    v_mfma_f32_32x32x16_bf16 v[112:127], v[156:159], v[220:223], v[112:127]
    s_waitcnt vmcnt(13)
    v_mfma_f32_32x32x16_bf16 v[16:31], v[160:163], v[224:227], v[16:31]
    v_mfma_f32_32x32x16_bf16 v[32:47], v[164:167], v[224:227], v[32:47]
    v_mfma_f32_32x32x16_bf16 v[96:111], v[160:163], v[228:231], v[96:111]
    v_mfma_f32_32x32x16_bf16 v[112:127], v[164:167], v[228:231], v[112:127]
    s_waitcnt vmcnt(11)
    v_mfma_f32_32x32x16_bf16 v[16:31], v[168:171], v[232:235], v[16:31]
    v_mfma_f32_32x32x16_bf16 v[32:47], v[172:175], v[232:235], v[32:47]
    v_mfma_f32_32x32x16_bf16 v[96:111], v[168:171], v[236:239], v[96:111]
    v_mfma_f32_32x32x16_bf16 v[112:127], v[172:175], v[236:239], v[112:127]
    s_waitcnt vmcnt(9)
    v_mfma_f32_32x32x16_bf16 v[16:31], v[176:179], v[240:243], v[16:31]
    v_mfma_f32_32x32x16_bf16 v[32:47], v[180:183], v[240:243], v[32:47]
    v_mfma_f32_32x32x16_bf16 v[96:111], v[176:179], v[244:247], v[96:111]
    v_mfma_f32_32x32x16_bf16 v[112:127], v[180:183], v[244:247], v[112:127]
    s_lshl_b32 s31, s22, 14
    v_add_u32 v6, s31, v3
    s_lshl_b32 s31, s22, 11
    v_add_u32 v7, s31, v3
    v_add_u32 v8, 0x10000, v7
    s_lshr_b32 s31, s37, 3
    s_lshl_b32 s31, s31, 18
    s_and_b32 s32, s37, 7
    s_lshl_b32 s32, s32, 10
    s_add_u32 s31, s31, s32
    s_lshl_b32 s32, s38, 5
    s_add_u32 s31, s31, s32
    v_and_b32 v9, 31, v2
    v_lshlrev_b32 v9, 13, v9
    v_lshl_add_u32 v9, v5, 4, v9
    ds_write_b128 v6, v[16:19] offset:0
    ds_write_b128 v6, v[20:23] offset:1024
    ds_write_b128 v6, v[24:27] offset:2048
    ds_write_b128 v6, v[28:31] offset:3072
    ds_write_b128 v6, v[32:35] offset:4096
    ds_write_b128 v6, v[36:39] offset:5120
    ds_write_b128 v6, v[40:43] offset:6144
    ds_write_b128 v6, v[44:47] offset:7168
    ds_write_b128 v6, v[96:99] offset:8192
    ds_write_b128 v6, v[100:103] offset:9216
    ds_write_b128 v6, v[104:107] offset:10240
    ds_write_b128 v6, v[108:111] offset:11264
    ds_write_b128 v6, v[112:115] offset:12288
    ds_write_b128 v6, v[116:119] offset:13312
    ds_write_b128 v6, v[120:123] offset:14336
    ds_write_b128 v6, v[124:127] offset:15360
    s_waitcnt vmcnt(0)
    v_pk_add_f32 v[72:73], v[72:73], v[80:81]
    v_pk_add_f32 v[74:75], v[74:75], v[82:83]
    v_pk_add_f32 v[76:77], v[76:77], v[84:85]
    v_pk_add_f32 v[78:79], v[78:79], v[86:87]
    v_pk_add_f32 v[72:73], v[72:73], v[88:89]
    v_pk_add_f32 v[74:75], v[74:75], v[90:91]
    v_pk_add_f32 v[76:77], v[76:77], v[92:93]
    v_pk_add_f32 v[78:79], v[78:79], v[94:95]
    v_pk_add_f32 v[72:73], v[72:73], v[48:49]
    v_pk_add_f32 v[74:75], v[74:75], v[50:51]
    v_pk_add_f32 v[76:77], v[76:77], v[52:53]
    v_pk_add_f32 v[78:79], v[78:79], v[54:55]
    v_cvt_pk_bf16_f32 v60, v72, v73
    v_cvt_pk_bf16_f32 v61, v74, v75
    v_cvt_pk_bf16_f32 v62, v76, v77
    v_cvt_pk_bf16_f32 v63, v78, v79
    v_lshlrev_b32 v72, 16, v60
    v_and_b32 v73, 0xffff0000, v60
    v_lshlrev_b32 v74, 16, v61
    v_and_b32 v75, 0xffff0000, v61
    v_lshlrev_b32 v76, 16, v62
    v_and_b32 v77, 0xffff0000, v62
    v_lshlrev_b32 v78, 16, v63
    v_and_b32 v79, 0xffff0000, v63
    v_lshlrev_b32 v80, 16, v64
    v_and_b32 v81, 0xffff0000, v64
    v_lshlrev_b32 v82, 16, v65
    v_and_b32 v83, 0xffff0000, v65
    v_lshlrev_b32 v84, 16, v66
    v_and_b32 v85, 0xffff0000, v66
    v_lshlrev_b32 v86, 16, v67
    v_and_b32 v87, 0xffff0000, v67
    s_waitcnt lgkmcnt(0)
    s_barrier
    ds_read_b128 v[192:195], v7 offset:0
    ds_read_b128 v[196:199], v7 offset:1024
    ds_read_b128 v[200:203], v7 offset:16384
    ds_read_b128 v[204:207], v7 offset:17408
    ds_read_b128 v[208:211], v7 offset:32768
    ds_read_b128 v[212:215], v7 offset:33792
    ds_read_b128 v[216:219], v7 offset:49152
    ds_read_b128 v[220:223], v7 offset:50176
    ds_read_b128 v[224:227], v8 offset:0
    ds_read_b128 v[228:231], v8 offset:1024
    ds_read_b128 v[232:235], v8 offset:16384
    ds_read_b128 v[236:239], v8 offset:17408
    ds_read_b128 v[240:243], v8 offset:32768
    ds_read_b128 v[244:247], v8 offset:33792
    ds_read_b128 v[248:251], v8 offset:49152
    ds_read_b128 v[252:255], v8 offset:50176
    s_waitcnt lgkmcnt(12)
    v_pk_add_f32 v[192:193], v[192:193], v[200:201]
    v_pk_add_f32 v[194:195], v[194:195], v[202:203]
    v_pk_add_f32 v[196:197], v[196:197], v[204:205]
    v_pk_add_f32 v[198:199], v[198:199], v[206:207]
    s_waitcnt lgkmcnt(10)
    v_pk_add_f32 v[192:193], v[192:193], v[208:209]
    v_pk_add_f32 v[194:195], v[194:195], v[210:211]
    v_pk_add_f32 v[196:197], v[196:197], v[212:213]
    v_pk_add_f32 v[198:199], v[198:199], v[214:215]
    s_waitcnt lgkmcnt(8)
    v_pk_add_f32 v[192:193], v[192:193], v[216:217]
    v_pk_add_f32 v[194:195], v[194:195], v[218:219]
    v_pk_add_f32 v[196:197], v[196:197], v[220:221]
    v_pk_add_f32 v[198:199], v[198:199], v[222:223]
    s_waitcnt lgkmcnt(6)
    v_pk_add_f32 v[192:193], v[192:193], v[224:225]
    v_pk_add_f32 v[194:195], v[194:195], v[226:227]
    v_pk_add_f32 v[196:197], v[196:197], v[228:229]
    v_pk_add_f32 v[198:199], v[198:199], v[230:231]
    s_waitcnt lgkmcnt(4)
    v_pk_add_f32 v[192:193], v[192:193], v[232:233]
    v_pk_add_f32 v[194:195], v[194:195], v[234:235]
    v_pk_add_f32 v[196:197], v[196:197], v[236:237]
    v_pk_add_f32 v[198:199], v[198:199], v[238:239]
    s_waitcnt lgkmcnt(2)
    v_pk_add_f32 v[192:193], v[192:193], v[240:241]
    v_pk_add_f32 v[194:195], v[194:195], v[242:243]
    v_pk_add_f32 v[196:197], v[196:197], v[244:245]
    v_pk_add_f32 v[198:199], v[198:199], v[246:247]
    s_waitcnt lgkmcnt(0)
    v_pk_add_f32 v[192:193], v[192:193], v[248:249]
    v_pk_add_f32 v[194:195], v[194:195], v[250:251]
    v_pk_add_f32 v[196:197], v[196:197], v[252:253]
    v_pk_add_f32 v[198:199], v[198:199], v[254:255]
    v_cvt_pk_bf16_f32 v60, v192, v193
    v_cvt_pk_bf16_f32 v61, v194, v195
    v_cvt_pk_bf16_f32 v62, v196, v197
    v_cvt_pk_bf16_f32 v63, v198, v199
    v_lshlrev_b32 v192, 16, v60
    v_and_b32 v193, 0xffff0000, v60
    v_lshlrev_b32 v194, 16, v61
    v_and_b32 v195, 0xffff0000, v61
    v_lshlrev_b32 v196, 16, v62
    v_and_b32 v197, 0xffff0000, v62
    v_lshlrev_b32 v198, 16, v63
    v_and_b32 v199, 0xffff0000, v63
    v_pk_mul_f32 v[192:193], v[192:193], v[72:73]
    v_pk_mul_f32 v[194:195], v[194:195], v[74:75]
    v_pk_mul_f32 v[196:197], v[196:197], v[76:77]
    v_pk_mul_f32 v[198:199], v[198:199], v[78:79]
    v_cvt_pk_bf16_f32 v60, v192, v193
    v_cvt_pk_bf16_f32 v61, v194, v195
    v_cvt_pk_bf16_f32 v62, v196, v197
    v_cvt_pk_bf16_f32 v63, v198, v199
    v_lshlrev_b32 v192, 16, v60
    v_and_b32 v193, 0xffff0000, v60
    v_lshlrev_b32 v194, 16, v61
    v_and_b32 v195, 0xffff0000, v61
    v_lshlrev_b32 v196, 16, v62
    v_and_b32 v197, 0xffff0000, v62
    v_lshlrev_b32 v198, 16, v63
    v_and_b32 v199, 0xffff0000, v63
    v_pk_add_f32 v[192:193], v[192:193], v[80:81]
    v_pk_add_f32 v[194:195], v[194:195], v[82:83]
    v_pk_add_f32 v[196:197], v[196:197], v[84:85]
    v_pk_add_f32 v[198:199], v[198:199], v[86:87]
    v_cvt_pk_bf16_f32 v60, v192, v193
    v_cvt_pk_bf16_f32 v61, v194, v195
    v_cvt_pk_bf16_f32 v62, v196, v197
    v_cvt_pk_bf16_f32 v63, v198, v199
    buffer_store_dwordx4 v[60:63], v9, s[40:43], s31 offen
KC_END:
    s_endpgm
.section .rodata,"a"
.p2align 6
.amdhsa_kernel kab_kernel
  .amdhsa_next_free_vgpr 252
  .amdhsa_next_free_sgpr 80
  .amdhsa_accum_offset 252
  .amdhsa_group_segment_fixed_size 0
  .amdhsa_kernarg_size 144
  .amdhsa_user_sgpr_count 2
  .amdhsa_user_sgpr_kernarg_segment_ptr 1
  .amdhsa_system_sgpr_workgroup_id_x 1
.end_amdhsa_kernel
.p2align 6
.amdhsa_kernel kc_kernel
  .amdhsa_next_free_vgpr 256
  .amdhsa_next_free_sgpr 64
  .amdhsa_accum_offset 256
  .amdhsa_group_segment_fixed_size 0
  .amdhsa_kernarg_size 144
  .amdhsa_user_sgpr_count 2
  .amdhsa_user_sgpr_kernarg_segment_ptr 1
  .amdhsa_system_sgpr_workgroup_id_x 1
.end_amdhsa_kernel
```
